```python
import torch

def _softmax(x, axis=-1):
    return torch.softmax(x, dim=axis)
def _gelu(x):
    return torch.nn.functional.gelu(x, approximate="tanh")
def _silu(x):
    return torch.nn.functional.silu(x)
def _sigmoid(x):
    return torch.sigmoid(x)
def _layernorm(x, axis=-1, eps=1e-5):
    m = x.mean(dim=axis, keepdim=True)
    v = x.var(dim=axis, keepdim=True, unbiased=False)
    return (x - m) / torch.sqrt(v + eps)
def _scatter_add(tgt, idx, src, axis=0):
    return tgt.clone().index_add_(axis, idx, src)
def _segment_sum(src, seg, n):
    out = torch.zeros((n,) + src.shape[1:], dtype=src.dtype)
    return out.index_add_(0, seg, src)
def _pad(x, pw):
    flat = tuple(v for pair in reversed(pw) for v in pair)
    return torch.nn.functional.pad(x, flat)

kernel_name = 'standalone__layernorm_linear__prompt'

def setup_inputs():

    _w = (lambda a: (lambda t: t.to(torch.bfloat16) if t.is_floating_point() else t)(torch.as_tensor(a)))
    B, S, D = 2, 2048, 1024
    return {
        "x": _w((lambda *s: torch.randn(*s, dtype=torch.bfloat16) * 0.05)(B, S, D)),
        "g": _w((lambda *s: torch.randn(*s, dtype=torch.bfloat16) * 0.05)(D) + 1.0),
        "b": _w((lambda *s: torch.randn(*s, dtype=torch.bfloat16) * 0.4)(D)),
        "w": _w((lambda *s: torch.randn(*s, dtype=torch.bfloat16) * 0.05)(D, D)),
    }

def reference(x, g, b, w):
    return (_layernorm(x, axis=-1) * g + b) @ w
```

```asm
; @launch grid=(256,1,1) block=(512,1,1) lds=163840
.amdgcn_target "amdgcn-amd-amdhsa--gfx950"
.text
.globl standalone__layernorm_linear__prompt_kernel
.p2align 8
.type standalone__layernorm_linear__prompt_kernel,@function
standalone__layernorm_linear__prompt_kernel:
s_cmp_ge_u32 s2, 0x100
s_cbranch_scc1 L_exit
s_load_dwordx2 s[12:13], s[0:1], 24
s_load_dwordx2 s[16:17], s[0:1], 8
s_load_dwordx2 s[8:9], s[0:1], 0
s_load_dwordx2 s[68:69], s[0:1], 16
s_load_dwordx2 s[60:61], s[0:1], 48
s_load_dwordx2 s[20:21], s[0:1], 32
v_lshrrev_b32 v1, 6, v0
v_and_b32 v0, 63, v0
v_readfirstlane_b32 s3, v1
s_mov_b32 s10, 0x800000
s_mov_b32 s11, 0x20000
s_mov_b32 s14, 0x200000
s_mov_b32 s15, 0x20000
s_mov_b32 s18, 0x800
s_mov_b32 s19, 0x20000
s_mov_b32 s70, 0x800
s_mov_b32 s71, 0x20000
s_mov_b32 s22, 0x800000
s_mov_b32 s23, 0x20000
s_mov_b32 s62, 0x300000
s_mov_b32 s63, 0x20000
s_and_b32 s4, s2, 7
s_lshr_b32 s5, s2, 3
s_and_b32 s6, s5, 3
s_lshl_b32 s4, s4, 2
s_add_u32 s4, s4, s6
s_lshr_b32 s5, s5, 2
s_mov_b32 s66, s3
s_mov_b32 s53, 0xffff0000
s_cmp_ge_u32 s3, 4
s_cbranch_scc1 L_dma
v_mov_b32 v114, v0
v_lshrrev_b32 v116, 4, v114
v_and_b32 v205, 15, v114
s_lshl_b32 s38, s4, 7
s_lshl_b32 s39, s5, 4
s_add_u32 s38, s38, s39
s_lshl_b32 s39, s3, 2
s_add_u32 s38, s38, s39
v_add_u32 v204, s38, v116
v_lshlrev_b32 v127, 11, v204
v_lshl_add_u32 v127, v205, 4, v127
s_and_b32 s6, s3, 1
s_lshr_b32 s7, s3, 1
v_and_b32 v117, 31, v114
v_lshrrev_b32 v118, 5, v114
v_bfe_u32 v119, v114, 1, 3
v_xor_b32 v119, v119, v118
v_lshlrev_b32 v119, 4, v119
s_lshl_b32 s37, s6, 13
v_lshl_add_u32 v125, v117, 7, v119
v_add_u32 v96, s37, v125
v_xor_b32 v97, 32, v96
v_xor_b32 v98, 64, v96
v_xor_b32 v99, 96, v96
v_add_u32 v100, 65536, v96
v_add_u32 v101, 65536, v97
v_add_u32 v102, 65536, v98
v_add_u32 v103, 65536, v99
v_add_u32 v104, 131072, v96
v_add_u32 v105, 131072, v97
v_add_u32 v106, 131072, v98
v_add_u32 v107, 131072, v99
v_lshrrev_b32 v117, 4, v114
v_bfe_u32 v118, v114, 2, 2
v_and_b32 v119, 3, v114
v_lshrrev_b32 v125, 1, v117
v_lshl_add_u32 v125, v125, 3, v118
v_lshlrev_b32 v125, 8, v125
v_and_b32 v117, 1, v117
v_lshlrev_b32 v117, 1, v117
v_lshrrev_b32 v126, 1, v119
v_add_u32 v117, v117, v126
s_lshl_b32 s37, s7, 3
v_add_u32 v117, s37, v117
v_lshlrev_b32 v118, 2, v118
v_xor_b32 v117, v117, v118
v_lshlrev_b32 v117, 4, v117
v_and_b32 v119, 1, v119
v_lshl_add_u32 v117, v119, 3, v117
v_add_u32 v117, v117, v125
v_add_u32 v108, 0x4000, v117
v_xor_b32 v109, 64, v108
v_add_u32 v110, 65536, v108
v_add_u32 v111, 65536, v109
v_add_u32 v112, 131072, v108
v_add_u32 v113, 131072, v109
v_lshrrev_b32 v117, 5, v114
v_lshlrev_b32 v117, 4, v117
s_lshl_b32 s37, s7, 8
s_add_u32 s37, s37, 32768
v_add_u32 v115, s37, v117
s_waitcnt lgkmcnt(0)
s_load_dword s64, s[60:61], 32768
v_lshrrev_b32 v117, 3, v114
v_lshlrev_b32 v117, 11, v117
v_and_b32 v118, 7, v114
v_lshrrev_b32 v119, 4, v114
v_xor_b32 v118, v118, v119
v_lshl_add_u32 v208, v118, 4, v117
v_xor_b32 v209, 64, v208
v_add_u32 v209, 15360, v209
s_lshl_b32 s37, s4, 18
s_lshl_b32 s39, s3, 16
s_add_u32 s50, s37, s39
s_lshl_b32 s51, s3, 12
s_barrier
buffer_load_dwordx4 v[128:131], v127, s[8:11], 0 offen offset:0
buffer_load_dwordx4 v[132:135], v127, s[8:11], 0 offen offset:256
buffer_load_dwordx4 v[136:139], v127, s[8:11], 0 offen offset:512
buffer_load_dwordx4 v[140:143], v127, s[8:11], 0 offen offset:768
s_barrier
s_mov_b32 s39, 0x3f803f80
v_mov_b32 v192, 0
v_mov_b32 v193, 0
v_mov_b32 v194, 0
v_mov_b32 v195, 0
v_mov_b32 v196, 0
v_mov_b32 v197, 0
v_mov_b32 v198, 0
v_mov_b32 v199, 0
s_waitcnt vmcnt(0)
v_dot2c_f32_bf16 v192, s39, v128
v_dot2c_f32_bf16 v193, s39, v129
v_dot2c_f32_bf16 v194, s39, v130
v_dot2c_f32_bf16 v195, s39, v131
v_dot2c_f32_bf16 v196, v128, v128
v_dot2c_f32_bf16 v197, v129, v129
v_dot2c_f32_bf16 v198, v130, v130
v_dot2c_f32_bf16 v199, v131, v131
v_dot2c_f32_bf16 v192, s39, v132
v_dot2c_f32_bf16 v193, s39, v133
v_dot2c_f32_bf16 v194, s39, v134
v_dot2c_f32_bf16 v195, s39, v135
v_dot2c_f32_bf16 v196, v132, v132
v_dot2c_f32_bf16 v197, v133, v133
v_dot2c_f32_bf16 v198, v134, v134
v_dot2c_f32_bf16 v199, v135, v135
v_dot2c_f32_bf16 v192, s39, v136
v_dot2c_f32_bf16 v193, s39, v137
v_dot2c_f32_bf16 v194, s39, v138
v_dot2c_f32_bf16 v195, s39, v139
v_dot2c_f32_bf16 v196, v136, v136
v_dot2c_f32_bf16 v197, v137, v137
v_dot2c_f32_bf16 v198, v138, v138
v_dot2c_f32_bf16 v199, v139, v139
v_dot2c_f32_bf16 v192, s39, v140
v_dot2c_f32_bf16 v193, s39, v141
v_dot2c_f32_bf16 v194, s39, v142
v_dot2c_f32_bf16 v195, s39, v143
v_dot2c_f32_bf16 v196, v140, v140
v_dot2c_f32_bf16 v197, v141, v141
v_dot2c_f32_bf16 v198, v142, v142
v_dot2c_f32_bf16 v199, v143, v143
s_waitcnt lgkmcnt(0)
s_add_u32 s64, s64, 2654435769
s_barrier
s_waitcnt vmcnt(0)
v_and_b32 v116, 31, v114
s_lshl_b32 s38, s6, 9
s_add_u32 s38, s38, 33792
v_lshl_add_u32 v218, v116, 3, s38
v_and_b32 v200, 7, v114
v_lshlrev_b32 v200, 4, v200
v_lshrrev_b32 v201, 5, v114
v_lshl_add_u32 v200, v201, 3, v200
v_lshl_add_u32 v212, v116, 7, v200
s_lshl_b32 s38, s3, 13
s_add_u32 s38, s38, 65536
v_add_u32 v212, s38, v212
v_lshrrev_b32 v200, 3, v114
v_and_b32 v201, 7, v114
v_xor_b32 v202, v201, v200
v_lshlrev_b32 v202, 4, v202
v_lshl_add_u32 v213, v200, 7, v202
v_add_u32 v213, s38, v213
v_lshlrev_b32 v214, 11, v200
v_lshl_add_u32 v214, v201, 4, v214
s_lshl_b32 s38, s4, 18
s_lshl_b32 s39, s6, 17
s_add_u32 s38, s38, s39
s_lshl_b32 s39, s5, 8
s_add_u32 s38, s38, s39
s_lshl_b32 s39, s7, 7
s_add_u32 s65, s38, s39
s_barrier
ds_read_b64_tr_b16 v[64:65], v108 offset:0
ds_read_b64_tr_b16 v[66:67], v108 offset:1024
ds_read_b128 v[72:75], v96 offset:0
ds_read_b128 v[76:79], v96 offset:4096
ds_read_b64_tr_b16 v[68:69], v109 offset:0
ds_read_b64_tr_b16 v[70:71], v109 offset:1024
s_waitcnt lgkmcnt(3)
v_mfma_f32_32x32x16_bf16 v[0:15], v[64:67], v[72:75], 0
ds_read_b64_tr_b16 v[80:81], v108 offset:4096
ds_read_b64_tr_b16 v[82:83], v108 offset:5120
s_waitcnt lgkmcnt(4)
v_mfma_f32_32x32x16_bf16 v[16:31], v[64:67], v[76:79], 0
ds_read_b128 v[88:91], v97 offset:0
ds_read_b128 v[92:95], v97 offset:4096
s_waitcnt lgkmcnt(4)
v_mfma_f32_32x32x16_bf16 v[48:63], v[68:71], v[76:79], 0
ds_read_b64_tr_b16 v[84:85], v109 offset:4096
ds_read_b64_tr_b16 v[86:87], v109 offset:5120
v_mfma_f32_32x32x16_bf16 v[32:47], v[68:71], v[72:75], 0
s_waitcnt lgkmcnt(3)
v_mfma_f32_32x32x16_bf16 v[0:15], v[80:83], v[88:91], v[0:15]
ds_read_b64_tr_b16 v[64:65], v108 offset:8192
ds_read_b64_tr_b16 v[66:67], v108 offset:9216
s_waitcnt lgkmcnt(4)
v_mfma_f32_32x32x16_bf16 v[16:31], v[80:83], v[92:95], v[16:31]
ds_read_b128 v[72:75], v98 offset:0
ds_read_b128 v[76:79], v98 offset:4096
s_waitcnt lgkmcnt(4)
v_mfma_f32_32x32x16_bf16 v[48:63], v[84:87], v[92:95], v[48:63]
ds_read_b64_tr_b16 v[68:69], v109 offset:8192
ds_read_b64_tr_b16 v[70:71], v109 offset:9216
v_mfma_f32_32x32x16_bf16 v[32:47], v[84:87], v[88:91], v[32:47]
s_waitcnt lgkmcnt(3)
v_mfma_f32_32x32x16_bf16 v[0:15], v[64:67], v[72:75], v[0:15]
ds_read_b64_tr_b16 v[80:81], v108 offset:12288
ds_read_b64_tr_b16 v[82:83], v108 offset:13312
ds_read_b128 v[88:91], v99 offset:0
s_waitcnt lgkmcnt(5)
v_mfma_f32_32x32x16_bf16 v[16:31], v[64:67], v[76:79], v[16:31]
ds_read_b128 v[92:95], v99 offset:4096
ds_read_b64_tr_b16 v[84:85], v109 offset:12288
ds_read_b64_tr_b16 v[86:87], v109 offset:13312
s_waitcnt lgkmcnt(6)
v_mfma_f32_32x32x16_bf16 v[48:63], v[68:71], v[76:79], v[48:63]
s_waitcnt lgkmcnt(0)
v_mfma_f32_32x32x16_bf16 v[32:47], v[68:71], v[72:75], v[32:47]
buffer_load_dwordx4 v[144:147], v127, s[8:11], 0 offen offset:1024
buffer_load_dwordx4 v[148:151], v127, s[8:11], 0 offen offset:1280
buffer_load_dwordx4 v[152:155], v127, s[8:11], 0 offen offset:1536
buffer_load_dwordx4 v[156:159], v127, s[8:11], 0 offen offset:1792
s_barrier
v_mfma_f32_32x32x16_bf16 v[0:15], v[80:83], v[88:91], v[0:15]
ds_read_b64_tr_b16 v[64:65], v108 offset:32768
ds_read_b64_tr_b16 v[66:67], v108 offset:33792
v_mfma_f32_32x32x16_bf16 v[16:31], v[80:83], v[92:95], v[16:31]
ds_read_b128 v[72:75], v96 offset:32768
ds_read_b128 v[76:79], v96 offset:36864
v_mfma_f32_32x32x16_bf16 v[48:63], v[84:87], v[92:95], v[48:63]
ds_read_b64_tr_b16 v[68:69], v109 offset:32768
ds_read_b64_tr_b16 v[70:71], v109 offset:33792
v_mfma_f32_32x32x16_bf16 v[32:47], v[84:87], v[88:91], v[32:47]
s_waitcnt lgkmcnt(3)
v_mfma_f32_32x32x16_bf16 v[0:15], v[64:67], v[72:75], v[0:15]
ds_read_b64_tr_b16 v[80:81], v108 offset:36864
ds_read_b64_tr_b16 v[82:83], v108 offset:37888
s_waitcnt lgkmcnt(4)
v_mfma_f32_32x32x16_bf16 v[16:31], v[64:67], v[76:79], v[16:31]
ds_read_b128 v[88:91], v97 offset:32768
ds_read_b128 v[92:95], v97 offset:36864
s_waitcnt lgkmcnt(4)
v_mfma_f32_32x32x16_bf16 v[48:63], v[68:71], v[76:79], v[48:63]
ds_read_b64_tr_b16 v[84:85], v109 offset:36864
ds_read_b64_tr_b16 v[86:87], v109 offset:37888
v_mfma_f32_32x32x16_bf16 v[32:47], v[68:71], v[72:75], v[32:47]
s_waitcnt lgkmcnt(3)
v_mfma_f32_32x32x16_bf16 v[0:15], v[80:83], v[88:91], v[0:15]
ds_read_b64_tr_b16 v[64:65], v108 offset:40960
ds_read_b64_tr_b16 v[66:67], v108 offset:41984
s_waitcnt lgkmcnt(4)
v_mfma_f32_32x32x16_bf16 v[16:31], v[80:83], v[92:95], v[16:31]
ds_read_b128 v[72:75], v98 offset:32768
ds_read_b128 v[76:79], v98 offset:36864
s_waitcnt lgkmcnt(4)
v_mfma_f32_32x32x16_bf16 v[48:63], v[84:87], v[92:95], v[48:63]
ds_read_b64_tr_b16 v[68:69], v109 offset:40960
ds_read_b64_tr_b16 v[70:71], v109 offset:41984
v_mfma_f32_32x32x16_bf16 v[32:47], v[84:87], v[88:91], v[32:47]
s_waitcnt lgkmcnt(3)
v_mfma_f32_32x32x16_bf16 v[0:15], v[64:67], v[72:75], v[0:15]
ds_read_b64_tr_b16 v[80:81], v108 offset:45056
ds_read_b64_tr_b16 v[82:83], v108 offset:46080
ds_read_b128 v[88:91], v99 offset:32768
s_waitcnt lgkmcnt(5)
v_mfma_f32_32x32x16_bf16 v[16:31], v[64:67], v[76:79], v[16:31]
ds_read_b128 v[92:95], v99 offset:36864
ds_read_b64_tr_b16 v[84:85], v109 offset:45056
ds_read_b64_tr_b16 v[86:87], v109 offset:46080
s_waitcnt lgkmcnt(6)
v_mfma_f32_32x32x16_bf16 v[48:63], v[68:71], v[76:79], v[48:63]
s_waitcnt lgkmcnt(0)
v_mfma_f32_32x32x16_bf16 v[32:47], v[68:71], v[72:75], v[32:47]
s_barrier
v_mfma_f32_32x32x16_bf16 v[0:15], v[80:83], v[88:91], v[0:15]
ds_read_b64_tr_b16 v[64:65], v110 offset:0
ds_read_b64_tr_b16 v[66:67], v110 offset:1024
v_mfma_f32_32x32x16_bf16 v[16:31], v[80:83], v[92:95], v[16:31]
ds_read_b128 v[72:75], v100 offset:0
ds_read_b128 v[76:79], v100 offset:4096
v_mfma_f32_32x32x16_bf16 v[48:63], v[84:87], v[92:95], v[48:63]
ds_read_b64_tr_b16 v[68:69], v111 offset:0
ds_read_b64_tr_b16 v[70:71], v111 offset:1024
v_mfma_f32_32x32x16_bf16 v[32:47], v[84:87], v[88:91], v[32:47]
s_waitcnt lgkmcnt(3)
v_mfma_f32_32x32x16_bf16 v[0:15], v[64:67], v[72:75], v[0:15]
ds_read_b64_tr_b16 v[80:81], v110 offset:4096
ds_read_b64_tr_b16 v[82:83], v110 offset:5120
s_waitcnt lgkmcnt(4)
v_mfma_f32_32x32x16_bf16 v[16:31], v[64:67], v[76:79], v[16:31]
ds_read_b128 v[88:91], v101 offset:0
ds_read_b128 v[92:95], v101 offset:4096
s_waitcnt lgkmcnt(4)
v_mfma_f32_32x32x16_bf16 v[48:63], v[68:71], v[76:79], v[48:63]
ds_read_b64_tr_b16 v[84:85], v111 offset:4096
ds_read_b64_tr_b16 v[86:87], v111 offset:5120
v_mfma_f32_32x32x16_bf16 v[32:47], v[68:71], v[72:75], v[32:47]
s_waitcnt lgkmcnt(3)
v_mfma_f32_32x32x16_bf16 v[0:15], v[80:83], v[88:91], v[0:15]
ds_read_b64_tr_b16 v[64:65], v110 offset:8192
ds_read_b64_tr_b16 v[66:67], v110 offset:9216
s_waitcnt lgkmcnt(4)
v_mfma_f32_32x32x16_bf16 v[16:31], v[80:83], v[92:95], v[16:31]
ds_read_b128 v[72:75], v102 offset:0
ds_read_b128 v[76:79], v102 offset:4096
s_waitcnt lgkmcnt(4)
v_mfma_f32_32x32x16_bf16 v[48:63], v[84:87], v[92:95], v[48:63]
ds_read_b64_tr_b16 v[68:69], v111 offset:8192
ds_read_b64_tr_b16 v[70:71], v111 offset:9216
v_mfma_f32_32x32x16_bf16 v[32:47], v[84:87], v[88:91], v[32:47]
s_waitcnt lgkmcnt(3)
v_mfma_f32_32x32x16_bf16 v[0:15], v[64:67], v[72:75], v[0:15]
ds_read_b64_tr_b16 v[80:81], v110 offset:12288
ds_read_b64_tr_b16 v[82:83], v110 offset:13312
ds_read_b128 v[88:91], v103 offset:0
s_waitcnt lgkmcnt(5)
v_mfma_f32_32x32x16_bf16 v[16:31], v[64:67], v[76:79], v[16:31]
ds_read_b128 v[92:95], v103 offset:4096
ds_read_b64_tr_b16 v[84:85], v111 offset:12288
ds_read_b64_tr_b16 v[86:87], v111 offset:13312
s_waitcnt lgkmcnt(6)
v_mfma_f32_32x32x16_bf16 v[48:63], v[68:71], v[76:79], v[48:63]
s_waitcnt lgkmcnt(0)
v_mfma_f32_32x32x16_bf16 v[32:47], v[68:71], v[72:75], v[32:47]
s_barrier
v_mfma_f32_32x32x16_bf16 v[0:15], v[80:83], v[88:91], v[0:15]
ds_read_b64_tr_b16 v[64:65], v110 offset:32768
ds_read_b64_tr_b16 v[66:67], v110 offset:33792
v_mfma_f32_32x32x16_bf16 v[16:31], v[80:83], v[92:95], v[16:31]
ds_read_b128 v[72:75], v100 offset:32768
ds_read_b128 v[76:79], v100 offset:36864
v_mfma_f32_32x32x16_bf16 v[48:63], v[84:87], v[92:95], v[48:63]
ds_read_b64_tr_b16 v[68:69], v111 offset:32768
ds_read_b64_tr_b16 v[70:71], v111 offset:33792
v_mfma_f32_32x32x16_bf16 v[32:47], v[84:87], v[88:91], v[32:47]
s_waitcnt lgkmcnt(3)
v_mfma_f32_32x32x16_bf16 v[0:15], v[64:67], v[72:75], v[0:15]
ds_read_b64_tr_b16 v[80:81], v110 offset:36864
ds_read_b64_tr_b16 v[82:83], v110 offset:37888
s_waitcnt lgkmcnt(4)
v_mfma_f32_32x32x16_bf16 v[16:31], v[64:67], v[76:79], v[16:31]
ds_read_b128 v[88:91], v101 offset:32768
ds_read_b128 v[92:95], v101 offset:36864
s_waitcnt lgkmcnt(4)
v_mfma_f32_32x32x16_bf16 v[48:63], v[68:71], v[76:79], v[48:63]
ds_read_b64_tr_b16 v[84:85], v111 offset:36864
ds_read_b64_tr_b16 v[86:87], v111 offset:37888
v_mfma_f32_32x32x16_bf16 v[32:47], v[68:71], v[72:75], v[32:47]
s_waitcnt lgkmcnt(3)
v_mfma_f32_32x32x16_bf16 v[0:15], v[80:83], v[88:91], v[0:15]
ds_read_b64_tr_b16 v[64:65], v110 offset:40960
ds_read_b64_tr_b16 v[66:67], v110 offset:41984
s_waitcnt lgkmcnt(4)
v_mfma_f32_32x32x16_bf16 v[16:31], v[80:83], v[92:95], v[16:31]
ds_read_b128 v[72:75], v102 offset:32768
ds_read_b128 v[76:79], v102 offset:36864
s_waitcnt lgkmcnt(4)
v_mfma_f32_32x32x16_bf16 v[48:63], v[84:87], v[92:95], v[48:63]
ds_read_b64_tr_b16 v[68:69], v111 offset:40960
ds_read_b64_tr_b16 v[70:71], v111 offset:41984
v_mfma_f32_32x32x16_bf16 v[32:47], v[84:87], v[88:91], v[32:47]
s_waitcnt lgkmcnt(3)
v_mfma_f32_32x32x16_bf16 v[0:15], v[64:67], v[72:75], v[0:15]
ds_read_b64_tr_b16 v[80:81], v110 offset:45056
ds_read_b64_tr_b16 v[82:83], v110 offset:46080
ds_read_b128 v[88:91], v103 offset:32768
s_waitcnt lgkmcnt(5)
v_mfma_f32_32x32x16_bf16 v[16:31], v[64:67], v[76:79], v[16:31]
ds_read_b128 v[92:95], v103 offset:36864
ds_read_b64_tr_b16 v[84:85], v111 offset:45056
ds_read_b64_tr_b16 v[86:87], v111 offset:46080
s_waitcnt lgkmcnt(6)
v_mfma_f32_32x32x16_bf16 v[48:63], v[68:71], v[76:79], v[48:63]
s_waitcnt lgkmcnt(0)
v_mfma_f32_32x32x16_bf16 v[32:47], v[68:71], v[72:75], v[32:47]
s_waitcnt vmcnt(0)
s_mov_b32 s39, 0x3f803f80
v_dot2c_f32_bf16 v192, s39, v144
v_dot2c_f32_bf16 v193, s39, v145
v_dot2c_f32_bf16 v194, s39, v146
v_dot2c_f32_bf16 v195, s39, v147
v_dot2c_f32_bf16 v196, v144, v144
v_dot2c_f32_bf16 v197, v145, v145
v_dot2c_f32_bf16 v198, v146, v146
v_dot2c_f32_bf16 v199, v147, v147
v_dot2c_f32_bf16 v192, s39, v148
v_dot2c_f32_bf16 v193, s39, v149
v_dot2c_f32_bf16 v194, s39, v150
v_dot2c_f32_bf16 v195, s39, v151
v_dot2c_f32_bf16 v196, v148, v148
v_dot2c_f32_bf16 v197, v149, v149
v_dot2c_f32_bf16 v198, v150, v150
v_dot2c_f32_bf16 v199, v151, v151
v_dot2c_f32_bf16 v192, s39, v152
v_dot2c_f32_bf16 v193, s39, v153
v_dot2c_f32_bf16 v194, s39, v154
v_dot2c_f32_bf16 v195, s39, v155
v_dot2c_f32_bf16 v196, v152, v152
v_dot2c_f32_bf16 v197, v153, v153
v_dot2c_f32_bf16 v198, v154, v154
v_dot2c_f32_bf16 v199, v155, v155
v_dot2c_f32_bf16 v192, s39, v156
v_dot2c_f32_bf16 v193, s39, v157
v_dot2c_f32_bf16 v194, s39, v158
v_dot2c_f32_bf16 v195, s39, v159
v_dot2c_f32_bf16 v196, v156, v156
v_dot2c_f32_bf16 v197, v157, v157
v_dot2c_f32_bf16 v198, v158, v158
v_dot2c_f32_bf16 v199, v159, v159
s_nop 2
v_add_f32 v192, v192, v193
v_add_f32 v194, v194, v195
v_add_f32 v196, v196, v197
v_add_f32 v198, v198, v199
v_add_f32 v200, v192, v194
v_add_f32 v203, v196, v198
s_nop 0
v_add_f32_dpp v200, v200, v200 row_ror:8 row_mask:0xf bank_mask:0xf
v_add_f32_dpp v203, v203, v203 row_ror:8 row_mask:0xf bank_mask:0xf
s_nop 0
s_nop 0
v_add_f32_dpp v200, v200, v200 row_ror:4 row_mask:0xf bank_mask:0xf
v_add_f32_dpp v203, v203, v203 row_ror:4 row_mask:0xf bank_mask:0xf
s_nop 0
s_nop 0
v_add_f32_dpp v200, v200, v200 row_ror:2 row_mask:0xf bank_mask:0xf
v_add_f32_dpp v203, v203, v203 row_ror:2 row_mask:0xf bank_mask:0xf
s_nop 0
s_nop 0
v_add_f32_dpp v200, v200, v200 row_ror:1 row_mask:0xf bank_mask:0xf
v_add_f32_dpp v203, v203, v203 row_ror:1 row_mask:0xf bank_mask:0xf
s_nop 0
v_mul_f32 v200, 0xba800000, v200
v_mul_f32 v203, 0x3a800000, v203
v_fma_f32 v203, -v200, v200, v203
v_max_f32 v203, 0, v203
v_add_f32 v203, 0x3727c5ac, v203
v_rsq_f32 v202, v203
s_nop 0
v_mul_f32 v203, v200, v202
v_lshlrev_b32 v204, 3, v204
v_cmp_eq_u32 vcc, 0, v205
s_and_saveexec_b64 s[76:77], vcc
buffer_store_dwordx2 v[202:203], v204, s[60:63], 0 offen sc1
s_mov_b64 exec, -1
s_barrier
v_mfma_f32_32x32x16_bf16 v[0:15], v[80:83], v[88:91], v[0:15]
ds_read_b64_tr_b16 v[64:65], v112 offset:0
ds_read_b64_tr_b16 v[66:67], v112 offset:1024
v_mfma_f32_32x32x16_bf16 v[16:31], v[80:83], v[92:95], v[16:31]
ds_read_b128 v[72:75], v104 offset:0
ds_read_b128 v[76:79], v104 offset:4096
v_mfma_f32_32x32x16_bf16 v[48:63], v[84:87], v[92:95], v[48:63]
ds_read_b64_tr_b16 v[68:69], v113 offset:0
ds_read_b64_tr_b16 v[70:71], v113 offset:1024
v_mfma_f32_32x32x16_bf16 v[32:47], v[84:87], v[88:91], v[32:47]
s_waitcnt lgkmcnt(3)
v_mfma_f32_32x32x16_bf16 v[0:15], v[64:67], v[72:75], v[0:15]
ds_read_b64_tr_b16 v[80:81], v112 offset:4096
ds_read_b64_tr_b16 v[82:83], v112 offset:5120
s_waitcnt lgkmcnt(4)
v_mfma_f32_32x32x16_bf16 v[16:31], v[64:67], v[76:79], v[16:31]
ds_read_b128 v[88:91], v105 offset:0
ds_read_b128 v[92:95], v105 offset:4096
s_waitcnt lgkmcnt(4)
v_mfma_f32_32x32x16_bf16 v[48:63], v[68:71], v[76:79], v[48:63]
ds_read_b64_tr_b16 v[84:85], v113 offset:4096
ds_read_b64_tr_b16 v[86:87], v113 offset:5120
v_mfma_f32_32x32x16_bf16 v[32:47], v[68:71], v[72:75], v[32:47]
s_waitcnt lgkmcnt(3)
v_mfma_f32_32x32x16_bf16 v[0:15], v[80:83], v[88:91], v[0:15]
ds_read_b64_tr_b16 v[64:65], v112 offset:8192
ds_read_b64_tr_b16 v[66:67], v112 offset:9216
s_waitcnt lgkmcnt(4)
v_mfma_f32_32x32x16_bf16 v[16:31], v[80:83], v[92:95], v[16:31]
ds_read_b128 v[72:75], v106 offset:0
ds_read_b128 v[76:79], v106 offset:4096
s_waitcnt lgkmcnt(4)
v_mfma_f32_32x32x16_bf16 v[48:63], v[84:87], v[92:95], v[48:63]
ds_read_b64_tr_b16 v[68:69], v113 offset:8192
ds_read_b64_tr_b16 v[70:71], v113 offset:9216
v_mfma_f32_32x32x16_bf16 v[32:47], v[84:87], v[88:91], v[32:47]
s_waitcnt lgkmcnt(3)
v_mfma_f32_32x32x16_bf16 v[0:15], v[64:67], v[72:75], v[0:15]
ds_read_b64_tr_b16 v[80:81], v112 offset:12288
ds_read_b64_tr_b16 v[82:83], v112 offset:13312
ds_read_b128 v[88:91], v107 offset:0
s_waitcnt lgkmcnt(5)
v_mfma_f32_32x32x16_bf16 v[16:31], v[64:67], v[76:79], v[16:31]
ds_read_b128 v[92:95], v107 offset:4096
ds_read_b64_tr_b16 v[84:85], v113 offset:12288
ds_read_b64_tr_b16 v[86:87], v113 offset:13312
s_waitcnt lgkmcnt(6)
v_mfma_f32_32x32x16_bf16 v[48:63], v[68:71], v[76:79], v[48:63]
s_waitcnt lgkmcnt(0)
v_mfma_f32_32x32x16_bf16 v[32:47], v[68:71], v[72:75], v[32:47]
s_barrier
v_mfma_f32_32x32x16_bf16 v[0:15], v[80:83], v[88:91], v[0:15]
ds_read_b64_tr_b16 v[64:65], v108 offset:0
ds_read_b64_tr_b16 v[66:67], v108 offset:1024
v_mfma_f32_32x32x16_bf16 v[16:31], v[80:83], v[92:95], v[16:31]
ds_read_b128 v[72:75], v96 offset:0
ds_read_b128 v[76:79], v96 offset:4096
v_mfma_f32_32x32x16_bf16 v[48:63], v[84:87], v[92:95], v[48:63]
ds_read_b64_tr_b16 v[68:69], v109 offset:0
ds_read_b64_tr_b16 v[70:71], v109 offset:1024
v_mfma_f32_32x32x16_bf16 v[32:47], v[84:87], v[88:91], v[32:47]
s_waitcnt lgkmcnt(3)
v_mfma_f32_32x32x16_bf16 v[0:15], v[64:67], v[72:75], v[0:15]
ds_read_b64_tr_b16 v[80:81], v108 offset:4096
ds_read_b64_tr_b16 v[82:83], v108 offset:5120
s_waitcnt lgkmcnt(4)
v_mfma_f32_32x32x16_bf16 v[16:31], v[64:67], v[76:79], v[16:31]
ds_read_b128 v[88:91], v97 offset:0
ds_read_b128 v[92:95], v97 offset:4096
s_waitcnt lgkmcnt(4)
v_mfma_f32_32x32x16_bf16 v[48:63], v[68:71], v[76:79], v[48:63]
ds_read_b64_tr_b16 v[84:85], v109 offset:4096
ds_read_b64_tr_b16 v[86:87], v109 offset:5120
v_mfma_f32_32x32x16_bf16 v[32:47], v[68:71], v[72:75], v[32:47]
s_waitcnt lgkmcnt(3)
v_mfma_f32_32x32x16_bf16 v[0:15], v[80:83], v[88:91], v[0:15]
ds_read_b64_tr_b16 v[64:65], v108 offset:8192
ds_read_b64_tr_b16 v[66:67], v108 offset:9216
s_waitcnt lgkmcnt(4)
v_mfma_f32_32x32x16_bf16 v[16:31], v[80:83], v[92:95], v[16:31]
ds_read_b128 v[72:75], v98 offset:0
ds_read_b128 v[76:79], v98 offset:4096
s_waitcnt lgkmcnt(4)
v_mfma_f32_32x32x16_bf16 v[48:63], v[84:87], v[92:95], v[48:63]
ds_read_b64_tr_b16 v[68:69], v109 offset:8192
ds_read_b64_tr_b16 v[70:71], v109 offset:9216
v_mfma_f32_32x32x16_bf16 v[32:47], v[84:87], v[88:91], v[32:47]
s_waitcnt lgkmcnt(3)
v_mfma_f32_32x32x16_bf16 v[0:15], v[64:67], v[72:75], v[0:15]
ds_read_b64_tr_b16 v[80:81], v108 offset:12288
ds_read_b64_tr_b16 v[82:83], v108 offset:13312
ds_read_b128 v[88:91], v99 offset:0
s_waitcnt lgkmcnt(5)
v_mfma_f32_32x32x16_bf16 v[16:31], v[64:67], v[76:79], v[16:31]
ds_read_b128 v[92:95], v99 offset:4096
ds_read_b64_tr_b16 v[84:85], v109 offset:12288
ds_read_b64_tr_b16 v[86:87], v109 offset:13312
s_waitcnt lgkmcnt(6)
v_mfma_f32_32x32x16_bf16 v[48:63], v[68:71], v[76:79], v[48:63]
s_waitcnt lgkmcnt(0)
v_mfma_f32_32x32x16_bf16 v[32:47], v[68:71], v[72:75], v[32:47]
s_waitcnt vmcnt(0)
s_lshl_b32 s38, s4, 7
s_lshl_b32 s39, s5, 4
s_add_u32 s38, s38, s39
s_lshl_b32 s39, s3, 2
s_add_u32 s38, s38, s39
s_add_u32 s38, s38, 45056
v_mov_b32 v117, s38
v_mov_b32 v118, s64
s_mov_b64 exec, 1
buffer_store_dword v118, v117, s[60:63], 0 offen sc1
s_mov_b64 exec, -1
s_barrier
v_mfma_f32_32x32x16_bf16 v[0:15], v[80:83], v[88:91], v[0:15]
ds_read_b64_tr_b16 v[64:65], v108 offset:32768
ds_read_b64_tr_b16 v[66:67], v108 offset:33792
v_mfma_f32_32x32x16_bf16 v[16:31], v[80:83], v[92:95], v[16:31]
ds_read_b128 v[72:75], v96 offset:32768
ds_read_b128 v[76:79], v96 offset:36864
v_mfma_f32_32x32x16_bf16 v[48:63], v[84:87], v[92:95], v[48:63]
ds_read_b64_tr_b16 v[68:69], v109 offset:32768
ds_read_b64_tr_b16 v[70:71], v109 offset:33792
v_mfma_f32_32x32x16_bf16 v[32:47], v[84:87], v[88:91], v[32:47]
s_waitcnt lgkmcnt(3)
v_mfma_f32_32x32x16_bf16 v[0:15], v[64:67], v[72:75], v[0:15]
ds_read_b64_tr_b16 v[80:81], v108 offset:36864
ds_read_b64_tr_b16 v[82:83], v108 offset:37888
s_waitcnt lgkmcnt(4)
v_mfma_f32_32x32x16_bf16 v[16:31], v[64:67], v[76:79], v[16:31]
ds_read_b128 v[88:91], v97 offset:32768
ds_read_b128 v[92:95], v97 offset:36864
s_waitcnt lgkmcnt(4)
v_mfma_f32_32x32x16_bf16 v[48:63], v[68:71], v[76:79], v[48:63]
ds_read_b64_tr_b16 v[84:85], v109 offset:36864
ds_read_b64_tr_b16 v[86:87], v109 offset:37888
v_mfma_f32_32x32x16_bf16 v[32:47], v[68:71], v[72:75], v[32:47]
s_waitcnt lgkmcnt(3)
v_mfma_f32_32x32x16_bf16 v[0:15], v[80:83], v[88:91], v[0:15]
ds_read_b64_tr_b16 v[64:65], v108 offset:40960
ds_read_b64_tr_b16 v[66:67], v108 offset:41984
s_waitcnt lgkmcnt(4)
v_mfma_f32_32x32x16_bf16 v[16:31], v[80:83], v[92:95], v[16:31]
ds_read_b128 v[72:75], v98 offset:32768
ds_read_b128 v[76:79], v98 offset:36864
s_waitcnt lgkmcnt(4)
v_mfma_f32_32x32x16_bf16 v[48:63], v[84:87], v[92:95], v[48:63]
ds_read_b64_tr_b16 v[68:69], v109 offset:40960
ds_read_b64_tr_b16 v[70:71], v109 offset:41984
v_mfma_f32_32x32x16_bf16 v[32:47], v[84:87], v[88:91], v[32:47]
s_waitcnt lgkmcnt(3)
v_mfma_f32_32x32x16_bf16 v[0:15], v[64:67], v[72:75], v[0:15]
ds_read_b64_tr_b16 v[80:81], v108 offset:45056
ds_read_b64_tr_b16 v[82:83], v108 offset:46080
ds_read_b128 v[88:91], v99 offset:32768
s_waitcnt lgkmcnt(5)
v_mfma_f32_32x32x16_bf16 v[16:31], v[64:67], v[76:79], v[16:31]
ds_read_b128 v[92:95], v99 offset:36864
ds_read_b64_tr_b16 v[84:85], v109 offset:45056
ds_read_b64_tr_b16 v[86:87], v109 offset:46080
s_waitcnt lgkmcnt(6)
v_mfma_f32_32x32x16_bf16 v[48:63], v[68:71], v[76:79], v[48:63]
s_waitcnt lgkmcnt(0)
v_mfma_f32_32x32x16_bf16 v[32:47], v[68:71], v[72:75], v[32:47]
s_barrier
v_mfma_f32_32x32x16_bf16 v[0:15], v[80:83], v[88:91], v[0:15]
ds_read_b64_tr_b16 v[64:65], v110 offset:0
ds_read_b64_tr_b16 v[66:67], v110 offset:1024
v_mfma_f32_32x32x16_bf16 v[16:31], v[80:83], v[92:95], v[16:31]
ds_read_b128 v[72:75], v100 offset:0
ds_read_b128 v[76:79], v100 offset:4096
v_mfma_f32_32x32x16_bf16 v[48:63], v[84:87], v[92:95], v[48:63]
ds_read_b64_tr_b16 v[68:69], v111 offset:0
ds_read_b64_tr_b16 v[70:71], v111 offset:1024
v_mfma_f32_32x32x16_bf16 v[32:47], v[84:87], v[88:91], v[32:47]
s_waitcnt lgkmcnt(3)
v_mfma_f32_32x32x16_bf16 v[0:15], v[64:67], v[72:75], v[0:15]
ds_read_b64_tr_b16 v[80:81], v110 offset:4096
ds_read_b64_tr_b16 v[82:83], v110 offset:5120
s_waitcnt lgkmcnt(4)
v_mfma_f32_32x32x16_bf16 v[16:31], v[64:67], v[76:79], v[16:31]
ds_read_b128 v[88:91], v101 offset:0
ds_read_b128 v[92:95], v101 offset:4096
s_waitcnt lgkmcnt(4)
v_mfma_f32_32x32x16_bf16 v[48:63], v[68:71], v[76:79], v[48:63]
ds_read_b64_tr_b16 v[84:85], v111 offset:4096
ds_read_b64_tr_b16 v[86:87], v111 offset:5120
v_mfma_f32_32x32x16_bf16 v[32:47], v[68:71], v[72:75], v[32:47]
s_waitcnt lgkmcnt(3)
v_mfma_f32_32x32x16_bf16 v[0:15], v[80:83], v[88:91], v[0:15]
ds_read_b64_tr_b16 v[64:65], v110 offset:8192
ds_read_b64_tr_b16 v[66:67], v110 offset:9216
s_waitcnt lgkmcnt(4)
v_mfma_f32_32x32x16_bf16 v[16:31], v[80:83], v[92:95], v[16:31]
ds_read_b128 v[72:75], v102 offset:0
ds_read_b128 v[76:79], v102 offset:4096
s_waitcnt lgkmcnt(4)
v_mfma_f32_32x32x16_bf16 v[48:63], v[84:87], v[92:95], v[48:63]
ds_read_b64_tr_b16 v[68:69], v111 offset:8192
ds_read_b64_tr_b16 v[70:71], v111 offset:9216
v_mfma_f32_32x32x16_bf16 v[32:47], v[84:87], v[88:91], v[32:47]
s_waitcnt lgkmcnt(3)
v_mfma_f32_32x32x16_bf16 v[0:15], v[64:67], v[72:75], v[0:15]
ds_read_b64_tr_b16 v[80:81], v110 offset:12288
ds_read_b64_tr_b16 v[82:83], v110 offset:13312
ds_read_b128 v[88:91], v103 offset:0
s_waitcnt lgkmcnt(5)
v_mfma_f32_32x32x16_bf16 v[16:31], v[64:67], v[76:79], v[16:31]
ds_read_b128 v[92:95], v103 offset:4096
ds_read_b64_tr_b16 v[84:85], v111 offset:12288
ds_read_b64_tr_b16 v[86:87], v111 offset:13312
s_waitcnt lgkmcnt(6)
v_mfma_f32_32x32x16_bf16 v[48:63], v[68:71], v[76:79], v[48:63]
s_waitcnt lgkmcnt(0)
v_mfma_f32_32x32x16_bf16 v[32:47], v[68:71], v[72:75], v[32:47]
s_barrier
v_mfma_f32_32x32x16_bf16 v[0:15], v[80:83], v[88:91], v[0:15]
ds_read_b64_tr_b16 v[64:65], v110 offset:32768
ds_read_b64_tr_b16 v[66:67], v110 offset:33792
v_mfma_f32_32x32x16_bf16 v[16:31], v[80:83], v[92:95], v[16:31]
ds_read_b128 v[72:75], v100 offset:32768
ds_read_b128 v[76:79], v100 offset:36864
v_mfma_f32_32x32x16_bf16 v[48:63], v[84:87], v[92:95], v[48:63]
ds_read_b64_tr_b16 v[68:69], v111 offset:32768
ds_read_b64_tr_b16 v[70:71], v111 offset:33792
v_mfma_f32_32x32x16_bf16 v[32:47], v[84:87], v[88:91], v[32:47]
s_waitcnt lgkmcnt(3)
v_mfma_f32_32x32x16_bf16 v[0:15], v[64:67], v[72:75], v[0:15]
ds_read_b64_tr_b16 v[80:81], v110 offset:36864
ds_read_b64_tr_b16 v[82:83], v110 offset:37888
s_waitcnt lgkmcnt(4)
v_mfma_f32_32x32x16_bf16 v[16:31], v[64:67], v[76:79], v[16:31]
ds_read_b128 v[88:91], v101 offset:32768
ds_read_b128 v[92:95], v101 offset:36864
s_waitcnt lgkmcnt(4)
v_mfma_f32_32x32x16_bf16 v[48:63], v[68:71], v[76:79], v[48:63]
ds_read_b64_tr_b16 v[84:85], v111 offset:36864
ds_read_b64_tr_b16 v[86:87], v111 offset:37888
v_mfma_f32_32x32x16_bf16 v[32:47], v[68:71], v[72:75], v[32:47]
s_waitcnt lgkmcnt(3)
v_mfma_f32_32x32x16_bf16 v[0:15], v[80:83], v[88:91], v[0:15]
ds_read_b64_tr_b16 v[64:65], v110 offset:40960
ds_read_b64_tr_b16 v[66:67], v110 offset:41984
s_waitcnt lgkmcnt(4)
v_mfma_f32_32x32x16_bf16 v[16:31], v[80:83], v[92:95], v[16:31]
ds_read_b128 v[72:75], v102 offset:32768
ds_read_b128 v[76:79], v102 offset:36864
s_waitcnt lgkmcnt(4)
v_mfma_f32_32x32x16_bf16 v[48:63], v[84:87], v[92:95], v[48:63]
ds_read_b64_tr_b16 v[68:69], v111 offset:40960
ds_read_b64_tr_b16 v[70:71], v111 offset:41984
v_mfma_f32_32x32x16_bf16 v[32:47], v[84:87], v[88:91], v[32:47]
s_waitcnt lgkmcnt(3)
v_mfma_f32_32x32x16_bf16 v[0:15], v[64:67], v[72:75], v[0:15]
ds_read_b64_tr_b16 v[80:81], v110 offset:45056
ds_read_b64_tr_b16 v[82:83], v110 offset:46080
ds_read_b128 v[88:91], v103 offset:32768
s_waitcnt lgkmcnt(5)
v_mfma_f32_32x32x16_bf16 v[16:31], v[64:67], v[76:79], v[16:31]
ds_read_b128 v[92:95], v103 offset:36864
ds_read_b64_tr_b16 v[84:85], v111 offset:45056
ds_read_b64_tr_b16 v[86:87], v111 offset:46080
s_waitcnt lgkmcnt(6)
v_mfma_f32_32x32x16_bf16 v[48:63], v[68:71], v[76:79], v[48:63]
s_waitcnt lgkmcnt(0)
v_mfma_f32_32x32x16_bf16 v[32:47], v[68:71], v[72:75], v[32:47]
s_barrier
v_mfma_f32_32x32x16_bf16 v[0:15], v[80:83], v[88:91], v[0:15]
ds_read_b64_tr_b16 v[64:65], v112 offset:0
ds_read_b64_tr_b16 v[66:67], v112 offset:1024
v_mfma_f32_32x32x16_bf16 v[16:31], v[80:83], v[92:95], v[16:31]
ds_read_b128 v[72:75], v104 offset:0
ds_read_b128 v[76:79], v104 offset:4096
v_mfma_f32_32x32x16_bf16 v[48:63], v[84:87], v[92:95], v[48:63]
ds_read_b64_tr_b16 v[68:69], v113 offset:0
ds_read_b64_tr_b16 v[70:71], v113 offset:1024
v_mfma_f32_32x32x16_bf16 v[32:47], v[84:87], v[88:91], v[32:47]
s_waitcnt lgkmcnt(3)
v_mfma_f32_32x32x16_bf16 v[0:15], v[64:67], v[72:75], v[0:15]
ds_read_b64_tr_b16 v[80:81], v112 offset:4096
ds_read_b64_tr_b16 v[82:83], v112 offset:5120
s_waitcnt lgkmcnt(4)
v_mfma_f32_32x32x16_bf16 v[16:31], v[64:67], v[76:79], v[16:31]
ds_read_b128 v[88:91], v105 offset:0
ds_read_b128 v[92:95], v105 offset:4096
s_waitcnt lgkmcnt(4)
v_mfma_f32_32x32x16_bf16 v[48:63], v[68:71], v[76:79], v[48:63]
ds_read_b64_tr_b16 v[84:85], v113 offset:4096
ds_read_b64_tr_b16 v[86:87], v113 offset:5120
v_mfma_f32_32x32x16_bf16 v[32:47], v[68:71], v[72:75], v[32:47]
s_waitcnt lgkmcnt(3)
v_mfma_f32_32x32x16_bf16 v[0:15], v[80:83], v[88:91], v[0:15]
ds_read_b64_tr_b16 v[64:65], v112 offset:8192
ds_read_b64_tr_b16 v[66:67], v112 offset:9216
s_waitcnt lgkmcnt(4)
v_mfma_f32_32x32x16_bf16 v[16:31], v[80:83], v[92:95], v[16:31]
ds_read_b128 v[72:75], v106 offset:0
ds_read_b128 v[76:79], v106 offset:4096
s_waitcnt lgkmcnt(4)
v_mfma_f32_32x32x16_bf16 v[48:63], v[84:87], v[92:95], v[48:63]
ds_read_b64_tr_b16 v[68:69], v113 offset:8192
ds_read_b64_tr_b16 v[70:71], v113 offset:9216
v_mfma_f32_32x32x16_bf16 v[32:47], v[84:87], v[88:91], v[32:47]
s_waitcnt lgkmcnt(3)
v_mfma_f32_32x32x16_bf16 v[0:15], v[64:67], v[72:75], v[0:15]
ds_read_b64_tr_b16 v[80:81], v112 offset:12288
ds_read_b64_tr_b16 v[82:83], v112 offset:13312
ds_read_b128 v[88:91], v107 offset:0
s_waitcnt lgkmcnt(5)
v_mfma_f32_32x32x16_bf16 v[16:31], v[64:67], v[76:79], v[16:31]
ds_read_b128 v[92:95], v107 offset:4096
ds_read_b64_tr_b16 v[84:85], v113 offset:12288
ds_read_b64_tr_b16 v[86:87], v113 offset:13312
s_waitcnt lgkmcnt(6)
v_mfma_f32_32x32x16_bf16 v[48:63], v[68:71], v[76:79], v[48:63]
s_waitcnt lgkmcnt(0)
v_mfma_f32_32x32x16_bf16 v[32:47], v[68:71], v[72:75], v[32:47]
s_barrier
v_mfma_f32_32x32x16_bf16 v[0:15], v[80:83], v[88:91], v[0:15]
ds_read_b64_tr_b16 v[64:65], v108 offset:0
ds_read_b64_tr_b16 v[66:67], v108 offset:1024
v_mfma_f32_32x32x16_bf16 v[16:31], v[80:83], v[92:95], v[16:31]
ds_read_b128 v[72:75], v96 offset:0
ds_read_b128 v[76:79], v96 offset:4096
v_mfma_f32_32x32x16_bf16 v[48:63], v[84:87], v[92:95], v[48:63]
ds_read_b64_tr_b16 v[68:69], v109 offset:0
ds_read_b64_tr_b16 v[70:71], v109 offset:1024
v_mfma_f32_32x32x16_bf16 v[32:47], v[84:87], v[88:91], v[32:47]
s_waitcnt lgkmcnt(3)
v_mfma_f32_32x32x16_bf16 v[0:15], v[64:67], v[72:75], v[0:15]
ds_read_b64_tr_b16 v[80:81], v108 offset:4096
ds_read_b64_tr_b16 v[82:83], v108 offset:5120
s_waitcnt lgkmcnt(4)
v_mfma_f32_32x32x16_bf16 v[16:31], v[64:67], v[76:79], v[16:31]
ds_read_b128 v[88:91], v97 offset:0
ds_read_b128 v[92:95], v97 offset:4096
s_waitcnt lgkmcnt(4)
v_mfma_f32_32x32x16_bf16 v[48:63], v[68:71], v[76:79], v[48:63]
ds_read_b64_tr_b16 v[84:85], v109 offset:4096
ds_read_b64_tr_b16 v[86:87], v109 offset:5120
v_mfma_f32_32x32x16_bf16 v[32:47], v[68:71], v[72:75], v[32:47]
s_waitcnt lgkmcnt(3)
v_mfma_f32_32x32x16_bf16 v[0:15], v[80:83], v[88:91], v[0:15]
ds_read_b64_tr_b16 v[64:65], v108 offset:8192
ds_read_b64_tr_b16 v[66:67], v108 offset:9216
s_waitcnt lgkmcnt(4)
v_mfma_f32_32x32x16_bf16 v[16:31], v[80:83], v[92:95], v[16:31]
ds_read_b128 v[72:75], v98 offset:0
ds_read_b128 v[76:79], v98 offset:4096
s_waitcnt lgkmcnt(4)
v_mfma_f32_32x32x16_bf16 v[48:63], v[84:87], v[92:95], v[48:63]
ds_read_b64_tr_b16 v[68:69], v109 offset:8192
ds_read_b64_tr_b16 v[70:71], v109 offset:9216
v_mfma_f32_32x32x16_bf16 v[32:47], v[84:87], v[88:91], v[32:47]
s_waitcnt lgkmcnt(3)
v_mfma_f32_32x32x16_bf16 v[0:15], v[64:67], v[72:75], v[0:15]
ds_read_b64_tr_b16 v[80:81], v108 offset:12288
ds_read_b64_tr_b16 v[82:83], v108 offset:13312
ds_read_b128 v[88:91], v99 offset:0
s_waitcnt lgkmcnt(5)
v_mfma_f32_32x32x16_bf16 v[16:31], v[64:67], v[76:79], v[16:31]
ds_read_b128 v[92:95], v99 offset:4096
ds_read_b64_tr_b16 v[84:85], v109 offset:12288
ds_read_b64_tr_b16 v[86:87], v109 offset:13312
s_waitcnt lgkmcnt(6)
v_mfma_f32_32x32x16_bf16 v[48:63], v[68:71], v[76:79], v[48:63]
s_waitcnt lgkmcnt(0)
v_mfma_f32_32x32x16_bf16 v[32:47], v[68:71], v[72:75], v[32:47]
s_barrier
v_mfma_f32_32x32x16_bf16 v[0:15], v[80:83], v[88:91], v[0:15]
ds_read_b64_tr_b16 v[64:65], v108 offset:32768
ds_read_b64_tr_b16 v[66:67], v108 offset:33792
v_mfma_f32_32x32x16_bf16 v[16:31], v[80:83], v[92:95], v[16:31]
ds_read_b128 v[72:75], v96 offset:32768
ds_read_b128 v[76:79], v96 offset:36864
v_mfma_f32_32x32x16_bf16 v[48:63], v[84:87], v[92:95], v[48:63]
ds_read_b64_tr_b16 v[68:69], v109 offset:32768
ds_read_b64_tr_b16 v[70:71], v109 offset:33792
v_mfma_f32_32x32x16_bf16 v[32:47], v[84:87], v[88:91], v[32:47]
s_waitcnt lgkmcnt(3)
v_mfma_f32_32x32x16_bf16 v[0:15], v[64:67], v[72:75], v[0:15]
ds_read_b64_tr_b16 v[80:81], v108 offset:36864
ds_read_b64_tr_b16 v[82:83], v108 offset:37888
s_waitcnt lgkmcnt(4)
v_mfma_f32_32x32x16_bf16 v[16:31], v[64:67], v[76:79], v[16:31]
ds_read_b128 v[88:91], v97 offset:32768
ds_read_b128 v[92:95], v97 offset:36864
s_waitcnt lgkmcnt(4)
v_mfma_f32_32x32x16_bf16 v[48:63], v[68:71], v[76:79], v[48:63]
ds_read_b64_tr_b16 v[84:85], v109 offset:36864
ds_read_b64_tr_b16 v[86:87], v109 offset:37888
v_mfma_f32_32x32x16_bf16 v[32:47], v[68:71], v[72:75], v[32:47]
s_waitcnt lgkmcnt(3)
v_mfma_f32_32x32x16_bf16 v[0:15], v[80:83], v[88:91], v[0:15]
ds_read_b64_tr_b16 v[64:65], v108 offset:40960
ds_read_b64_tr_b16 v[66:67], v108 offset:41984
s_waitcnt lgkmcnt(4)
v_mfma_f32_32x32x16_bf16 v[16:31], v[80:83], v[92:95], v[16:31]
ds_read_b128 v[72:75], v98 offset:32768
ds_read_b128 v[76:79], v98 offset:36864
s_waitcnt lgkmcnt(4)
v_mfma_f32_32x32x16_bf16 v[48:63], v[84:87], v[92:95], v[48:63]
ds_read_b64_tr_b16 v[68:69], v109 offset:40960
ds_read_b64_tr_b16 v[70:71], v109 offset:41984
v_mfma_f32_32x32x16_bf16 v[32:47], v[84:87], v[88:91], v[32:47]
s_waitcnt lgkmcnt(3)
v_mfma_f32_32x32x16_bf16 v[0:15], v[64:67], v[72:75], v[0:15]
ds_read_b64_tr_b16 v[80:81], v108 offset:45056
ds_read_b64_tr_b16 v[82:83], v108 offset:46080
ds_read_b128 v[88:91], v99 offset:32768
s_waitcnt lgkmcnt(5)
v_mfma_f32_32x32x16_bf16 v[16:31], v[64:67], v[76:79], v[16:31]
ds_read_b128 v[92:95], v99 offset:36864
ds_read_b64_tr_b16 v[84:85], v109 offset:45056
ds_read_b64_tr_b16 v[86:87], v109 offset:46080
s_waitcnt lgkmcnt(6)
v_mfma_f32_32x32x16_bf16 v[48:63], v[68:71], v[76:79], v[48:63]
s_waitcnt lgkmcnt(0)
v_mfma_f32_32x32x16_bf16 v[32:47], v[68:71], v[72:75], v[32:47]
s_barrier
v_mfma_f32_32x32x16_bf16 v[0:15], v[80:83], v[88:91], v[0:15]
ds_read_b64_tr_b16 v[64:65], v110 offset:0
ds_read_b64_tr_b16 v[66:67], v110 offset:1024
v_mfma_f32_32x32x16_bf16 v[16:31], v[80:83], v[92:95], v[16:31]
ds_read_b128 v[72:75], v100 offset:0
ds_read_b128 v[76:79], v100 offset:4096
v_mfma_f32_32x32x16_bf16 v[48:63], v[84:87], v[92:95], v[48:63]
ds_read_b64_tr_b16 v[68:69], v111 offset:0
ds_read_b64_tr_b16 v[70:71], v111 offset:1024
v_mfma_f32_32x32x16_bf16 v[32:47], v[84:87], v[88:91], v[32:47]
s_waitcnt lgkmcnt(3)
v_mfma_f32_32x32x16_bf16 v[0:15], v[64:67], v[72:75], v[0:15]
ds_read_b64_tr_b16 v[80:81], v110 offset:4096
ds_read_b64_tr_b16 v[82:83], v110 offset:5120
s_waitcnt lgkmcnt(4)
v_mfma_f32_32x32x16_bf16 v[16:31], v[64:67], v[76:79], v[16:31]
ds_read_b128 v[88:91], v101 offset:0
ds_read_b128 v[92:95], v101 offset:4096
s_waitcnt lgkmcnt(4)
v_mfma_f32_32x32x16_bf16 v[48:63], v[68:71], v[76:79], v[48:63]
ds_read_b64_tr_b16 v[84:85], v111 offset:4096
ds_read_b64_tr_b16 v[86:87], v111 offset:5120
v_mfma_f32_32x32x16_bf16 v[32:47], v[68:71], v[72:75], v[32:47]
s_waitcnt lgkmcnt(3)
v_mfma_f32_32x32x16_bf16 v[0:15], v[80:83], v[88:91], v[0:15]
ds_read_b64_tr_b16 v[64:65], v110 offset:8192
ds_read_b64_tr_b16 v[66:67], v110 offset:9216
s_waitcnt lgkmcnt(4)
v_mfma_f32_32x32x16_bf16 v[16:31], v[80:83], v[92:95], v[16:31]
ds_read_b128 v[72:75], v102 offset:0
ds_read_b128 v[76:79], v102 offset:4096
s_waitcnt lgkmcnt(4)
v_mfma_f32_32x32x16_bf16 v[48:63], v[84:87], v[92:95], v[48:63]
ds_read_b64_tr_b16 v[68:69], v111 offset:8192
ds_read_b64_tr_b16 v[70:71], v111 offset:9216
v_mfma_f32_32x32x16_bf16 v[32:47], v[84:87], v[88:91], v[32:47]
s_waitcnt lgkmcnt(3)
v_mfma_f32_32x32x16_bf16 v[0:15], v[64:67], v[72:75], v[0:15]
ds_read_b64_tr_b16 v[80:81], v110 offset:12288
ds_read_b64_tr_b16 v[82:83], v110 offset:13312
ds_read_b128 v[88:91], v103 offset:0
s_waitcnt lgkmcnt(5)
v_mfma_f32_32x32x16_bf16 v[16:31], v[64:67], v[76:79], v[16:31]
ds_read_b128 v[92:95], v103 offset:4096
ds_read_b64_tr_b16 v[84:85], v111 offset:12288
ds_read_b64_tr_b16 v[86:87], v111 offset:13312
s_waitcnt lgkmcnt(6)
v_mfma_f32_32x32x16_bf16 v[48:63], v[68:71], v[76:79], v[48:63]
s_waitcnt lgkmcnt(0)
v_mfma_f32_32x32x16_bf16 v[32:47], v[68:71], v[72:75], v[32:47]
s_barrier
v_mfma_f32_32x32x16_bf16 v[0:15], v[80:83], v[88:91], v[0:15]
ds_read_b64_tr_b16 v[64:65], v110 offset:32768
ds_read_b64_tr_b16 v[66:67], v110 offset:33792
v_mfma_f32_32x32x16_bf16 v[16:31], v[80:83], v[92:95], v[16:31]
ds_read_b128 v[72:75], v100 offset:32768
ds_read_b128 v[76:79], v100 offset:36864
v_mfma_f32_32x32x16_bf16 v[48:63], v[84:87], v[92:95], v[48:63]
ds_read_b64_tr_b16 v[68:69], v111 offset:32768
ds_read_b64_tr_b16 v[70:71], v111 offset:33792
v_mfma_f32_32x32x16_bf16 v[32:47], v[84:87], v[88:91], v[32:47]
s_waitcnt lgkmcnt(3)
v_mfma_f32_32x32x16_bf16 v[0:15], v[64:67], v[72:75], v[0:15]
ds_read_b64_tr_b16 v[80:81], v110 offset:36864
ds_read_b64_tr_b16 v[82:83], v110 offset:37888
s_waitcnt lgkmcnt(4)
v_mfma_f32_32x32x16_bf16 v[16:31], v[64:67], v[76:79], v[16:31]
ds_read_b128 v[88:91], v101 offset:32768
ds_read_b128 v[92:95], v101 offset:36864
s_waitcnt lgkmcnt(4)
v_mfma_f32_32x32x16_bf16 v[48:63], v[68:71], v[76:79], v[48:63]
ds_read_b64_tr_b16 v[84:85], v111 offset:36864
ds_read_b64_tr_b16 v[86:87], v111 offset:37888
v_mfma_f32_32x32x16_bf16 v[32:47], v[68:71], v[72:75], v[32:47]
s_waitcnt lgkmcnt(3)
v_mfma_f32_32x32x16_bf16 v[0:15], v[80:83], v[88:91], v[0:15]
ds_read_b64_tr_b16 v[64:65], v110 offset:40960
ds_read_b64_tr_b16 v[66:67], v110 offset:41984
s_waitcnt lgkmcnt(4)
v_mfma_f32_32x32x16_bf16 v[16:31], v[80:83], v[92:95], v[16:31]
ds_read_b128 v[72:75], v102 offset:32768
ds_read_b128 v[76:79], v102 offset:36864
s_waitcnt lgkmcnt(4)
v_mfma_f32_32x32x16_bf16 v[48:63], v[84:87], v[92:95], v[48:63]
ds_read_b64_tr_b16 v[68:69], v111 offset:40960
ds_read_b64_tr_b16 v[70:71], v111 offset:41984
v_mfma_f32_32x32x16_bf16 v[32:47], v[84:87], v[88:91], v[32:47]
s_waitcnt lgkmcnt(3)
v_mfma_f32_32x32x16_bf16 v[0:15], v[64:67], v[72:75], v[0:15]
ds_read_b64_tr_b16 v[80:81], v110 offset:45056
ds_read_b64_tr_b16 v[82:83], v110 offset:46080
ds_read_b128 v[88:91], v103 offset:32768
s_waitcnt lgkmcnt(5)
v_mfma_f32_32x32x16_bf16 v[16:31], v[64:67], v[76:79], v[16:31]
ds_read_b128 v[92:95], v103 offset:36864
ds_read_b64_tr_b16 v[84:85], v111 offset:45056
ds_read_b64_tr_b16 v[86:87], v111 offset:46080
s_waitcnt lgkmcnt(6)
v_mfma_f32_32x32x16_bf16 v[48:63], v[68:71], v[76:79], v[48:63]
s_waitcnt lgkmcnt(0)
v_mfma_f32_32x32x16_bf16 v[32:47], v[68:71], v[72:75], v[32:47]
s_barrier
v_mfma_f32_32x32x16_bf16 v[0:15], v[80:83], v[88:91], v[0:15]
ds_read_b64_tr_b16 v[64:65], v112 offset:0
ds_read_b64_tr_b16 v[66:67], v112 offset:1024
v_mfma_f32_32x32x16_bf16 v[16:31], v[80:83], v[92:95], v[16:31]
ds_read_b128 v[72:75], v104 offset:0
ds_read_b128 v[76:79], v104 offset:4096
v_mfma_f32_32x32x16_bf16 v[48:63], v[84:87], v[92:95], v[48:63]
ds_read_b64_tr_b16 v[68:69], v113 offset:0
ds_read_b64_tr_b16 v[70:71], v113 offset:1024
v_mfma_f32_32x32x16_bf16 v[32:47], v[84:87], v[88:91], v[32:47]
s_waitcnt lgkmcnt(3)
v_mfma_f32_32x32x16_bf16 v[0:15], v[64:67], v[72:75], v[0:15]
ds_read_b64_tr_b16 v[80:81], v112 offset:4096
ds_read_b64_tr_b16 v[82:83], v112 offset:5120
s_waitcnt lgkmcnt(4)
v_mfma_f32_32x32x16_bf16 v[16:31], v[64:67], v[76:79], v[16:31]
ds_read_b128 v[88:91], v105 offset:0
ds_read_b128 v[92:95], v105 offset:4096
s_waitcnt lgkmcnt(4)
v_mfma_f32_32x32x16_bf16 v[48:63], v[68:71], v[76:79], v[48:63]
ds_read_b64_tr_b16 v[84:85], v113 offset:4096
ds_read_b64_tr_b16 v[86:87], v113 offset:5120
v_mfma_f32_32x32x16_bf16 v[32:47], v[68:71], v[72:75], v[32:47]
s_waitcnt lgkmcnt(3)
v_mfma_f32_32x32x16_bf16 v[0:15], v[80:83], v[88:91], v[0:15]
ds_read_b64_tr_b16 v[64:65], v112 offset:8192
ds_read_b64_tr_b16 v[66:67], v112 offset:9216
s_waitcnt lgkmcnt(4)
v_mfma_f32_32x32x16_bf16 v[16:31], v[80:83], v[92:95], v[16:31]
ds_read_b128 v[72:75], v106 offset:0
ds_read_b128 v[76:79], v106 offset:4096
s_waitcnt lgkmcnt(4)
v_mfma_f32_32x32x16_bf16 v[48:63], v[84:87], v[92:95], v[48:63]
ds_read_b64_tr_b16 v[68:69], v113 offset:8192
ds_read_b64_tr_b16 v[70:71], v113 offset:9216
v_mfma_f32_32x32x16_bf16 v[32:47], v[84:87], v[88:91], v[32:47]
s_waitcnt lgkmcnt(3)
v_mfma_f32_32x32x16_bf16 v[0:15], v[64:67], v[72:75], v[0:15]
ds_read_b64_tr_b16 v[80:81], v112 offset:12288
ds_read_b64_tr_b16 v[82:83], v112 offset:13312
ds_read_b128 v[88:91], v107 offset:0
s_waitcnt lgkmcnt(5)
v_mfma_f32_32x32x16_bf16 v[16:31], v[64:67], v[76:79], v[16:31]
ds_read_b128 v[92:95], v107 offset:4096
ds_read_b64_tr_b16 v[84:85], v113 offset:12288
ds_read_b64_tr_b16 v[86:87], v113 offset:13312
s_waitcnt lgkmcnt(6)
v_mfma_f32_32x32x16_bf16 v[48:63], v[68:71], v[76:79], v[48:63]
s_waitcnt lgkmcnt(0)
v_mfma_f32_32x32x16_bf16 v[32:47], v[68:71], v[72:75], v[32:47]
s_barrier
v_mfma_f32_32x32x16_bf16 v[0:15], v[80:83], v[88:91], v[0:15]
ds_read_b64_tr_b16 v[64:65], v108 offset:0
ds_read_b64_tr_b16 v[66:67], v108 offset:1024
v_mfma_f32_32x32x16_bf16 v[16:31], v[80:83], v[92:95], v[16:31]
ds_read_b128 v[72:75], v96 offset:0
ds_read_b128 v[76:79], v96 offset:4096
v_mfma_f32_32x32x16_bf16 v[48:63], v[84:87], v[92:95], v[48:63]
ds_read_b64_tr_b16 v[68:69], v109 offset:0
ds_read_b64_tr_b16 v[70:71], v109 offset:1024
v_mfma_f32_32x32x16_bf16 v[32:47], v[84:87], v[88:91], v[32:47]
s_waitcnt lgkmcnt(3)
v_mfma_f32_32x32x16_bf16 v[0:15], v[64:67], v[72:75], v[0:15]
ds_read_b64_tr_b16 v[80:81], v108 offset:4096
ds_read_b64_tr_b16 v[82:83], v108 offset:5120
s_waitcnt lgkmcnt(4)
v_mfma_f32_32x32x16_bf16 v[16:31], v[64:67], v[76:79], v[16:31]
ds_read_b128 v[88:91], v97 offset:0
ds_read_b128 v[92:95], v97 offset:4096
s_waitcnt lgkmcnt(4)
v_mfma_f32_32x32x16_bf16 v[48:63], v[68:71], v[76:79], v[48:63]
ds_read_b64_tr_b16 v[84:85], v109 offset:4096
ds_read_b64_tr_b16 v[86:87], v109 offset:5120
v_mfma_f32_32x32x16_bf16 v[32:47], v[68:71], v[72:75], v[32:47]
ds_read_b64 v[192:193], v218
ds_read_b64 v[194:195], v218 offset:256
ds_read_b128 v[128:131], v115 offset:0
ds_read_b128 v[160:163], v115 offset:512
ds_read_b128 v[132:135], v115 offset:32
ds_read_b128 v[164:167], v115 offset:544
s_waitcnt lgkmcnt(9)
v_mfma_f32_32x32x16_bf16 v[0:15], v[80:83], v[88:91], v[0:15]
ds_read_b64_tr_b16 v[64:65], v108 offset:8192
ds_read_b64_tr_b16 v[66:67], v108 offset:9216
s_waitcnt lgkmcnt(10)
v_mfma_f32_32x32x16_bf16 v[16:31], v[80:83], v[92:95], v[16:31]
ds_read_b128 v[72:75], v98 offset:0
ds_read_b128 v[76:79], v98 offset:4096
s_waitcnt lgkmcnt(10)
v_mfma_f32_32x32x16_bf16 v[48:63], v[84:87], v[92:95], v[48:63]
ds_read_b64_tr_b16 v[68:69], v109 offset:8192
ds_read_b64_tr_b16 v[70:71], v109 offset:9216
v_mfma_f32_32x32x16_bf16 v[32:47], v[84:87], v[88:91], v[32:47]
ds_read_b128 v[136:139], v115 offset:64
ds_read_b128 v[168:171], v115 offset:576
ds_read_b128 v[140:143], v115 offset:96
ds_read_b128 v[172:175], v115 offset:608
ds_read_b128 v[144:147], v115 offset:128
ds_read_b128 v[176:179], v115 offset:640
s_waitcnt lgkmcnt(9)
v_mfma_f32_32x32x16_bf16 v[0:15], v[64:67], v[72:75], v[0:15]
ds_read_b64_tr_b16 v[80:81], v108 offset:12288
ds_read_b64_tr_b16 v[82:83], v108 offset:13312
s_waitcnt lgkmcnt(10)
v_mfma_f32_32x32x16_bf16 v[16:31], v[64:67], v[76:79], v[16:31]
ds_read_b128 v[88:91], v99 offset:0
ds_read_b128 v[92:95], v99 offset:4096
s_waitcnt lgkmcnt(10)
v_mfma_f32_32x32x16_bf16 v[48:63], v[68:71], v[76:79], v[48:63]
ds_read_b64_tr_b16 v[84:85], v109 offset:12288
ds_read_b64_tr_b16 v[86:87], v109 offset:13312
v_mfma_f32_32x32x16_bf16 v[32:47], v[68:71], v[72:75], v[32:47]
ds_read_b128 v[148:151], v115 offset:160
ds_read_b128 v[180:183], v115 offset:672
ds_read_b128 v[152:155], v115 offset:192
ds_read_b128 v[184:187], v115 offset:704
ds_read_b128 v[156:159], v115 offset:224
ds_read_b128 v[188:191], v115 offset:736
s_waitcnt lgkmcnt(9)
v_mfma_f32_32x32x16_bf16 v[0:15], v[80:83], v[88:91], v[0:15]
s_waitcnt lgkmcnt(6)
v_mfma_f32_32x32x16_bf16 v[32:47], v[84:87], v[88:91], v[32:47]
v_mfma_f32_32x32x16_bf16 v[48:63], v[84:87], v[92:95], v[48:63]
v_mfma_f32_32x32x16_bf16 v[16:31], v[80:83], v[92:95], v[16:31]
s_nop 7
v_pk_fma_f32 v[200:201], v[128:129], v[192:193], v[160:161] op_sel:[0,1,0] op_sel_hi:[1,1,1]
v_pk_fma_f32 v[202:203], v[130:131], v[192:193], v[162:163] op_sel:[0,1,0] op_sel_hi:[1,1,1]
v_pk_fma_f32 v[200:201], v[0:1], v[192:193], v[200:201] op_sel_hi:[1,0,1]
v_pk_fma_f32 v[202:203], v[2:3], v[192:193], v[202:203] op_sel_hi:[1,0,1]
v_xor_b32 v216, 0, v212
v_cvt_pk_bf16_f32 v208, v200, v201
v_cvt_pk_bf16_f32 v209, v202, v203
ds_write_b64 v216, v[208:209] offset:0
v_pk_fma_f32 v[204:205], v[132:133], v[192:193], v[164:165] op_sel:[0,1,0] op_sel_hi:[1,1,1]
v_pk_fma_f32 v[206:207], v[134:135], v[192:193], v[166:167] op_sel:[0,1,0] op_sel_hi:[1,1,1]
v_pk_fma_f32 v[204:205], v[4:5], v[192:193], v[204:205] op_sel_hi:[1,0,1]
v_pk_fma_f32 v[206:207], v[6:7], v[192:193], v[206:207] op_sel_hi:[1,0,1]
v_xor_b32 v217, 16, v212
v_cvt_pk_bf16_f32 v210, v204, v205
v_cvt_pk_bf16_f32 v211, v206, v207
ds_write_b64 v217, v[210:211] offset:0
v_pk_fma_f32 v[200:201], v[136:137], v[192:193], v[168:169] op_sel:[0,1,0] op_sel_hi:[1,1,1]
v_pk_fma_f32 v[202:203], v[138:139], v[192:193], v[170:171] op_sel:[0,1,0] op_sel_hi:[1,1,1]
v_pk_fma_f32 v[200:201], v[8:9], v[192:193], v[200:201] op_sel_hi:[1,0,1]
v_pk_fma_f32 v[202:203], v[10:11], v[192:193], v[202:203] op_sel_hi:[1,0,1]
v_xor_b32 v216, 32, v212
v_cvt_pk_bf16_f32 v208, v200, v201
v_cvt_pk_bf16_f32 v209, v202, v203
ds_write_b64 v216, v[208:209] offset:0
v_pk_fma_f32 v[204:205], v[140:141], v[192:193], v[172:173] op_sel:[0,1,0] op_sel_hi:[1,1,1]
v_pk_fma_f32 v[206:207], v[142:143], v[192:193], v[174:175] op_sel:[0,1,0] op_sel_hi:[1,1,1]
v_pk_fma_f32 v[204:205], v[12:13], v[192:193], v[204:205] op_sel_hi:[1,0,1]
v_pk_fma_f32 v[206:207], v[14:15], v[192:193], v[206:207] op_sel_hi:[1,0,1]
v_xor_b32 v217, 48, v212
v_cvt_pk_bf16_f32 v210, v204, v205
v_cvt_pk_bf16_f32 v211, v206, v207
ds_write_b64 v217, v[210:211] offset:0
v_pk_fma_f32 v[200:201], v[144:145], v[192:193], v[176:177] op_sel:[0,1,0] op_sel_hi:[1,1,1]
v_pk_fma_f32 v[202:203], v[146:147], v[192:193], v[178:179] op_sel:[0,1,0] op_sel_hi:[1,1,1]
v_pk_fma_f32 v[200:201], v[32:33], v[192:193], v[200:201] op_sel_hi:[1,0,1]
v_pk_fma_f32 v[202:203], v[34:35], v[192:193], v[202:203] op_sel_hi:[1,0,1]
v_xor_b32 v216, 64, v212
v_cvt_pk_bf16_f32 v208, v200, v201
v_cvt_pk_bf16_f32 v209, v202, v203
ds_write_b64 v216, v[208:209] offset:0
s_waitcnt lgkmcnt(9)
v_pk_fma_f32 v[204:205], v[148:149], v[192:193], v[180:181] op_sel:[0,1,0] op_sel_hi:[1,1,1]
v_pk_fma_f32 v[206:207], v[150:151], v[192:193], v[182:183] op_sel:[0,1,0] op_sel_hi:[1,1,1]
v_pk_fma_f32 v[204:205], v[36:37], v[192:193], v[204:205] op_sel_hi:[1,0,1]
v_pk_fma_f32 v[206:207], v[38:39], v[192:193], v[206:207] op_sel_hi:[1,0,1]
v_xor_b32 v217, 80, v212
v_cvt_pk_bf16_f32 v210, v204, v205
v_cvt_pk_bf16_f32 v211, v206, v207
ds_write_b64 v217, v[210:211] offset:0
s_waitcnt lgkmcnt(8)
v_pk_fma_f32 v[200:201], v[152:153], v[192:193], v[184:185] op_sel:[0,1,0] op_sel_hi:[1,1,1]
v_pk_fma_f32 v[202:203], v[154:155], v[192:193], v[186:187] op_sel:[0,1,0] op_sel_hi:[1,1,1]
v_pk_fma_f32 v[200:201], v[40:41], v[192:193], v[200:201] op_sel_hi:[1,0,1]
v_pk_fma_f32 v[202:203], v[42:43], v[192:193], v[202:203] op_sel_hi:[1,0,1]
v_xor_b32 v216, 96, v212
v_cvt_pk_bf16_f32 v208, v200, v201
v_cvt_pk_bf16_f32 v209, v202, v203
ds_write_b64 v216, v[208:209] offset:0
s_waitcnt lgkmcnt(7)
v_pk_fma_f32 v[204:205], v[156:157], v[192:193], v[188:189] op_sel:[0,1,0] op_sel_hi:[1,1,1]
v_pk_fma_f32 v[206:207], v[158:159], v[192:193], v[190:191] op_sel:[0,1,0] op_sel_hi:[1,1,1]
v_pk_fma_f32 v[204:205], v[44:45], v[192:193], v[204:205] op_sel_hi:[1,0,1]
v_pk_fma_f32 v[206:207], v[46:47], v[192:193], v[206:207] op_sel_hi:[1,0,1]
v_xor_b32 v217, 112, v212
v_cvt_pk_bf16_f32 v210, v204, v205
v_cvt_pk_bf16_f32 v211, v206, v207
ds_write_b64 v217, v[210:211] offset:0
ds_read_b128 v[0:3], v213 offset:0
ds_read_b128 v[4:7], v213 offset:1024
ds_read_b128 v[8:11], v213 offset:2048
ds_read_b128 v[12:15], v213 offset:3072
v_pk_fma_f32 v[200:201], v[128:129], v[194:195], v[160:161] op_sel:[0,1,0] op_sel_hi:[1,1,1]
v_pk_fma_f32 v[202:203], v[130:131], v[194:195], v[162:163] op_sel:[0,1,0] op_sel_hi:[1,1,1]
v_pk_fma_f32 v[200:201], v[16:17], v[194:195], v[200:201] op_sel_hi:[1,0,1]
v_pk_fma_f32 v[202:203], v[18:19], v[194:195], v[202:203] op_sel_hi:[1,0,1]
v_xor_b32 v216, 0, v212
v_cvt_pk_bf16_f32 v208, v200, v201
v_cvt_pk_bf16_f32 v209, v202, v203
ds_write_b64 v216, v[208:209] offset:4096
v_pk_fma_f32 v[204:205], v[132:133], v[194:195], v[164:165] op_sel:[0,1,0] op_sel_hi:[1,1,1]
v_pk_fma_f32 v[206:207], v[134:135], v[194:195], v[166:167] op_sel:[0,1,0] op_sel_hi:[1,1,1]
v_pk_fma_f32 v[204:205], v[20:21], v[194:195], v[204:205] op_sel_hi:[1,0,1]
v_pk_fma_f32 v[206:207], v[22:23], v[194:195], v[206:207] op_sel_hi:[1,0,1]
v_xor_b32 v217, 16, v212
v_cvt_pk_bf16_f32 v210, v204, v205
v_cvt_pk_bf16_f32 v211, v206, v207
ds_write_b64 v217, v[210:211] offset:4096
s_waitcnt lgkmcnt(5)
s_add_u32 s51, s65, 0
buffer_store_dwordx4 v[0:3], v214, s[20:23], s51 offen sc1 nt
s_waitcnt lgkmcnt(4)
s_add_u32 s51, s65, 16384
buffer_store_dwordx4 v[4:7], v214, s[20:23], s51 offen sc1 nt
v_pk_fma_f32 v[200:201], v[136:137], v[194:195], v[168:169] op_sel:[0,1,0] op_sel_hi:[1,1,1]
v_pk_fma_f32 v[202:203], v[138:139], v[194:195], v[170:171] op_sel:[0,1,0] op_sel_hi:[1,1,1]
v_pk_fma_f32 v[200:201], v[24:25], v[194:195], v[200:201] op_sel_hi:[1,0,1]
v_pk_fma_f32 v[202:203], v[26:27], v[194:195], v[202:203] op_sel_hi:[1,0,1]
v_xor_b32 v216, 32, v212
v_cvt_pk_bf16_f32 v208, v200, v201
v_cvt_pk_bf16_f32 v209, v202, v203
ds_write_b64 v216, v[208:209] offset:4096
s_waitcnt lgkmcnt(4)
s_add_u32 s51, s65, 32768
buffer_store_dwordx4 v[8:11], v214, s[20:23], s51 offen sc1 nt
s_waitcnt lgkmcnt(3)
s_add_u32 s51, s65, 49152
buffer_store_dwordx4 v[12:15], v214, s[20:23], s51 offen sc1 nt
v_pk_fma_f32 v[204:205], v[140:141], v[194:195], v[172:173] op_sel:[0,1,0] op_sel_hi:[1,1,1]
v_pk_fma_f32 v[206:207], v[142:143], v[194:195], v[174:175] op_sel:[0,1,0] op_sel_hi:[1,1,1]
v_pk_fma_f32 v[204:205], v[28:29], v[194:195], v[204:205] op_sel_hi:[1,0,1]
v_pk_fma_f32 v[206:207], v[30:31], v[194:195], v[206:207] op_sel_hi:[1,0,1]
v_xor_b32 v217, 48, v212
v_cvt_pk_bf16_f32 v210, v204, v205
v_cvt_pk_bf16_f32 v211, v206, v207
ds_write_b64 v217, v[210:211] offset:4096
v_pk_fma_f32 v[200:201], v[144:145], v[194:195], v[176:177] op_sel:[0,1,0] op_sel_hi:[1,1,1]
v_pk_fma_f32 v[202:203], v[146:147], v[194:195], v[178:179] op_sel:[0,1,0] op_sel_hi:[1,1,1]
v_pk_fma_f32 v[200:201], v[48:49], v[194:195], v[200:201] op_sel_hi:[1,0,1]
v_pk_fma_f32 v[202:203], v[50:51], v[194:195], v[202:203] op_sel_hi:[1,0,1]
v_xor_b32 v216, 64, v212
v_cvt_pk_bf16_f32 v208, v200, v201
v_cvt_pk_bf16_f32 v209, v202, v203
ds_write_b64 v216, v[208:209] offset:4096
v_pk_fma_f32 v[204:205], v[148:149], v[194:195], v[180:181] op_sel:[0,1,0] op_sel_hi:[1,1,1]
v_pk_fma_f32 v[206:207], v[150:151], v[194:195], v[182:183] op_sel:[0,1,0] op_sel_hi:[1,1,1]
v_pk_fma_f32 v[204:205], v[52:53], v[194:195], v[204:205] op_sel_hi:[1,0,1]
v_pk_fma_f32 v[206:207], v[54:55], v[194:195], v[206:207] op_sel_hi:[1,0,1]
v_xor_b32 v217, 80, v212
v_cvt_pk_bf16_f32 v210, v204, v205
v_cvt_pk_bf16_f32 v211, v206, v207
ds_write_b64 v217, v[210:211] offset:4096
v_pk_fma_f32 v[200:201], v[152:153], v[194:195], v[184:185] op_sel:[0,1,0] op_sel_hi:[1,1,1]
v_pk_fma_f32 v[202:203], v[154:155], v[194:195], v[186:187] op_sel:[0,1,0] op_sel_hi:[1,1,1]
v_pk_fma_f32 v[200:201], v[56:57], v[194:195], v[200:201] op_sel_hi:[1,0,1]
v_pk_fma_f32 v[202:203], v[58:59], v[194:195], v[202:203] op_sel_hi:[1,0,1]
v_xor_b32 v216, 96, v212
v_cvt_pk_bf16_f32 v208, v200, v201
v_cvt_pk_bf16_f32 v209, v202, v203
ds_write_b64 v216, v[208:209] offset:4096
v_pk_fma_f32 v[204:205], v[156:157], v[194:195], v[188:189] op_sel:[0,1,0] op_sel_hi:[1,1,1]
v_pk_fma_f32 v[206:207], v[158:159], v[194:195], v[190:191] op_sel:[0,1,0] op_sel_hi:[1,1,1]
v_pk_fma_f32 v[204:205], v[60:61], v[194:195], v[204:205] op_sel_hi:[1,0,1]
v_pk_fma_f32 v[206:207], v[62:63], v[194:195], v[206:207] op_sel_hi:[1,0,1]
v_xor_b32 v217, 112, v212
v_cvt_pk_bf16_f32 v210, v204, v205
v_cvt_pk_bf16_f32 v211, v206, v207
ds_write_b64 v217, v[210:211] offset:4096
ds_read_b128 v[16:19], v213 offset:4096
ds_read_b128 v[20:23], v213 offset:5120
ds_read_b128 v[24:27], v213 offset:6144
ds_read_b128 v[28:31], v213 offset:7168
s_waitcnt lgkmcnt(3)
s_add_u32 s51, s65, 65536
buffer_store_dwordx4 v[16:19], v214, s[20:23], s51 offen sc1 nt
s_waitcnt lgkmcnt(2)
s_add_u32 s51, s65, 81920
buffer_store_dwordx4 v[20:23], v214, s[20:23], s51 offen sc1 nt
s_waitcnt lgkmcnt(1)
s_add_u32 s51, s65, 98304
buffer_store_dwordx4 v[24:27], v214, s[20:23], s51 offen sc1 nt
s_waitcnt lgkmcnt(0)
s_add_u32 s51, s65, 114688
buffer_store_dwordx4 v[28:31], v214, s[20:23], s51 offen sc1 nt
s_branch L_end
L_dma:
s_sub_u32 s3, s3, 4
v_lshrrev_b32 v100, 2, v0
v_and_b32 v101, 3, v0
v_lshlrev_b32 v102, 11, v100
v_lshl_add_u32 v102, v101, 4, v102
v_lshlrev_b32 v103, 1, v100
v_mov_b32 v72, 0
v_mov_b32 v73, 0
v_mov_b32 v74, 0
v_mov_b32 v75, 0
s_lshl_b32 s38, s4, 16
s_lshl_b32 s39, s5, 8
s_add_u32 s38, s38, s39
s_lshl_b32 s39, s3, 6
s_add_u32 s38, s38, s39
s_add_u32 s39, s38, 0x8000
s_lshl_b32 s36, s4, 6
s_waitcnt lgkmcnt(0)
buffer_load_dwordx4 v[64:67], v102, s[12:15], s38 offen
buffer_load_short_d16_hi v72, v103, s[16:19], s36 offen
buffer_load_dwordx4 v[68:71], v102, s[12:15], s39 offen
buffer_load_short_d16_hi v73, v103, s[16:19], s36 offen offset:32
buffer_load_short_d16_hi v74, v103, s[68:71], s36 offen
buffer_load_short_d16_hi v75, v103, s[68:71], s36 offen offset:32
s_load_dword s64, s[60:61], 32768
v_lshrrev_b32 v8, 3, v0
v_lshlrev_b32 v8, 11, v8
v_and_b32 v9, 7, v0
v_lshrrev_b32 v11, 4, v0
v_xor_b32 v9, v9, v11
v_lshl_add_u32 v2, v9, 4, v8
v_xor_b32 v3, 64, v2
v_add_u32 v3, 15360, v3
v_lshlrev_b32 v10, 4, v0
s_lshl_b32 s37, s4, 18
s_lshl_b32 s39, s3, 16
s_add_u32 s50, s37, s39
s_lshl_b32 s51, s3, 12
s_lshl_b32 s37, s5, 18
s_add_u32 s52, s37, s51
s_add_u32 s52, s52, 1048576
v_and_b32 v97, 3, v100
v_lshlrev_b32 v97, 2, v97
s_lshl_b32 s37, s3, 2
v_add_u32 v98, s37, v101
v_xor_b32 v97, v97, v98
v_lshlrev_b32 v97, 4, v97
v_lshl_add_u32 v104, v100, 8, v97
s_lshl_b32 s38, s5, 18
s_lshl_b32 s39, s4, 13
s_add_u32 s38, s38, s39
s_add_u32 s38, s38, 1048576
s_add_u32 s39, s38, 0x1000
s_waitcnt vmcnt(4)
v_lshlrev_b32 v76, 16, v64
v_and_b32 v77, s53, v64
v_lshlrev_b32 v78, 16, v65
v_and_b32 v79, s53, v65
v_lshlrev_b32 v80, 16, v66
v_and_b32 v81, s53, v66
v_lshlrev_b32 v82, 16, v67
v_and_b32 v83, s53, v67
v_mul_f32 v76, v72, v76
v_mul_f32 v77, v72, v77
v_mul_f32 v78, v72, v78
v_mul_f32 v79, v72, v79
v_mul_f32 v80, v72, v80
v_mul_f32 v81, v72, v81
v_mul_f32 v82, v72, v82
v_mul_f32 v83, v72, v83
v_cvt_pk_bf16_f32 v84, v76, v77
v_cvt_pk_bf16_f32 v85, v78, v79
v_cvt_pk_bf16_f32 v86, v80, v81
v_cvt_pk_bf16_f32 v87, v82, v83
buffer_store_dwordx4 v[84:87], v104, s[60:63], s38 offen sc1
s_waitcnt vmcnt(3)
v_lshlrev_b32 v76, 16, v68
v_and_b32 v77, s53, v68
v_lshlrev_b32 v78, 16, v69
v_and_b32 v79, s53, v69
v_lshlrev_b32 v80, 16, v70
v_and_b32 v81, s53, v70
v_lshlrev_b32 v82, 16, v71
v_and_b32 v83, s53, v71
v_mul_f32 v76, v73, v76
v_mul_f32 v77, v73, v77
v_mul_f32 v78, v73, v78
v_mul_f32 v79, v73, v79
v_mul_f32 v80, v73, v80
v_mul_f32 v81, v73, v81
v_mul_f32 v82, v73, v82
v_mul_f32 v83, v73, v83
v_cvt_pk_bf16_f32 v88, v76, v77
v_cvt_pk_bf16_f32 v89, v78, v79
v_cvt_pk_bf16_f32 v90, v80, v81
v_cvt_pk_bf16_f32 v91, v82, v83
buffer_store_dwordx4 v[88:91], v104, s[60:63], s39 offen sc1
s_barrier
s_waitcnt vmcnt(0)
s_waitcnt lgkmcnt(0)
s_add_u32 s64, s64, 2654435769
s_barrier
s_cmp_lg_u32 s3, 0
s_cbranch_scc1 L_noflagw
s_lshl_b32 s38, s5, 10
s_lshl_b32 s39, s4, 2
s_add_u32 s38, s38, s39
s_add_u32 s38, s38, 49152
v_lshlrev_b32 v97, 7, v0
v_add_u32 v97, s38, v97
v_mov_b32 v98, s64
s_mov_b64 exec, 0xff
buffer_store_dword v98, v97, s[60:63], 0 offen sc1
s_mov_b64 exec, -1
L_noflagw:
v_lshlrev_b32 v76, 16, v64
v_and_b32 v77, s53, v64
v_lshlrev_b32 v78, 16, v65
v_and_b32 v79, s53, v65
v_lshlrev_b32 v80, 16, v66
v_and_b32 v81, s53, v66
v_lshlrev_b32 v82, 16, v67
v_and_b32 v83, s53, v67
v_mul_f32 v120, v74, v76
v_mul_f32 v121, v74, v77
v_mul_f32 v122, v74, v78
v_mul_f32 v123, v74, v79
v_mul_f32 v124, v74, v80
v_mul_f32 v125, v74, v81
v_mul_f32 v126, v74, v82
v_mul_f32 v127, v74, v83
v_lshlrev_b32 v112, 16, v84
v_and_b32 v113, s53, v84
v_lshlrev_b32 v114, 16, v85
v_and_b32 v115, s53, v85
v_lshlrev_b32 v116, 16, v86
v_and_b32 v117, s53, v86
v_lshlrev_b32 v118, 16, v87
v_and_b32 v119, s53, v87
v_lshlrev_b32 v76, 16, v68
v_and_b32 v77, s53, v68
v_lshlrev_b32 v78, 16, v69
v_and_b32 v79, s53, v69
v_lshlrev_b32 v80, 16, v70
v_and_b32 v81, s53, v70
v_lshlrev_b32 v82, 16, v71
v_and_b32 v83, s53, v71
v_fmac_f32 v120, v75, v76
v_fmac_f32 v121, v75, v77
v_fmac_f32 v122, v75, v78
v_fmac_f32 v123, v75, v79
v_fmac_f32 v124, v75, v80
v_fmac_f32 v125, v75, v81
v_fmac_f32 v126, v75, v82
v_fmac_f32 v127, v75, v83
v_lshlrev_b32 v76, 16, v88
v_and_b32 v77, s53, v88
v_lshlrev_b32 v78, 16, v89
v_and_b32 v79, s53, v89
v_lshlrev_b32 v80, 16, v90
v_and_b32 v81, s53, v90
v_lshlrev_b32 v82, 16, v91
v_and_b32 v83, s53, v91
v_add_f32 v112, v112, v76
v_add_f32 v113, v113, v77
v_add_f32 v114, v114, v78
v_add_f32 v115, v115, v79
v_add_f32 v116, v116, v80
v_add_f32 v117, v117, v81
v_add_f32 v118, v118, v82
v_add_f32 v119, v119, v83
s_nop 1
v_permlane32_swap_b32 v112, v120
v_permlane32_swap_b32 v113, v121
v_permlane32_swap_b32 v114, v122
v_permlane32_swap_b32 v115, v123
v_permlane32_swap_b32 v116, v124
v_permlane32_swap_b32 v117, v125
v_permlane32_swap_b32 v118, v126
v_permlane32_swap_b32 v119, v127
s_nop 1
v_add_f32 v112, v112, v120
v_add_f32 v113, v113, v121
v_add_f32 v114, v114, v122
v_add_f32 v115, v115, v123
v_add_f32 v116, v116, v124
v_add_f32 v117, v117, v125
v_add_f32 v118, v118, v126
v_add_f32 v119, v119, v127
s_nop 1
v_permlane16_swap_b32 v112, v116
v_permlane16_swap_b32 v113, v117
v_permlane16_swap_b32 v114, v118
v_permlane16_swap_b32 v115, v119
s_nop 1
v_add_f32 v112, v112, v116
v_add_f32 v113, v113, v117
v_add_f32 v114, v114, v118
v_add_f32 v115, v115, v119
s_nop 1
v_add_f32_dpp v112, v112, v112 row_ror:8 row_mask:0xf bank_mask:0xf
v_add_f32_dpp v113, v113, v113 row_ror:8 row_mask:0xf bank_mask:0xf
v_add_f32_dpp v114, v114, v114 row_ror:8 row_mask:0xf bank_mask:0xf
v_add_f32_dpp v115, v115, v115 row_ror:8 row_mask:0xf bank_mask:0xf
s_nop 1
v_add_f32_dpp v112, v112, v112 row_ror:4 row_mask:0xf bank_mask:0xf
v_add_f32_dpp v113, v113, v113 row_ror:4 row_mask:0xf bank_mask:0xf
v_add_f32_dpp v114, v114, v114 row_ror:4 row_mask:0xf bank_mask:0xf
v_add_f32_dpp v115, v115, v115 row_ror:4 row_mask:0xf bank_mask:0xf
v_lshrrev_b32 v97, 4, v0
v_lshrrev_b32 v98, 1, v97
v_lshlrev_b32 v98, 9, v98
v_and_b32 v97, 1, v97
v_lshl_add_u32 v98, v97, 4, v98
v_lshl_add_u32 v98, v101, 5, v98
s_lshl_b32 s38, s5, 5
s_add_u32 s38, s38, s4
s_lshl_b32 s38, s38, 10
s_lshl_b32 s39, s3, 7
s_add_u32 s38, s38, s39
s_add_u32 s38, s38, 65536
v_and_b32 v97, 15, v0
v_cmp_gt_u32 vcc, 4, v97
s_and_saveexec_b64 s[76:77], vcc
buffer_store_dwordx4 v[112:115], v98, s[60:63], s38 offen sc1
s_mov_b64 exec, -1
s_add_u32 m0, s51, 0
s_add_u32 s54, s50, 0
buffer_load_dwordx4 v2, s[8:11], s54 offen lds
buffer_load_dwordx4 v3, s[8:11], s54 offen offset:1024 lds
s_add_u32 m0, s51, 2048
s_add_u32 s54, s54, 32768
buffer_load_dwordx4 v2, s[8:11], s54 offen lds
buffer_load_dwordx4 v3, s[8:11], s54 offen offset:1024 lds
s_add_u32 m0, s51, 32768
s_add_u32 s54, s50, 128
buffer_load_dwordx4 v2, s[8:11], s54 offen lds
buffer_load_dwordx4 v3, s[8:11], s54 offen offset:1024 lds
s_add_u32 m0, s51, 34816
s_add_u32 s54, s54, 32768
buffer_load_dwordx4 v2, s[8:11], s54 offen lds
buffer_load_dwordx4 v3, s[8:11], s54 offen offset:1024 lds
s_add_u32 m0, s51, 65536
s_add_u32 s54, s50, 256
buffer_load_dwordx4 v2, s[8:11], s54 offen lds
buffer_load_dwordx4 v3, s[8:11], s54 offen offset:1024 lds
s_add_u32 m0, s51, 67584
s_add_u32 s54, s54, 32768
buffer_load_dwordx4 v2, s[8:11], s54 offen lds
buffer_load_dwordx4 v3, s[8:11], s54 offen offset:1024 lds
s_add_u32 m0, s51, 98304
s_add_u32 s54, s50, 384
buffer_load_dwordx4 v2, s[8:11], s54 offen lds
buffer_load_dwordx4 v3, s[8:11], s54 offen offset:1024 lds
s_add_u32 m0, s51, 100352
s_add_u32 s54, s54, 32768
buffer_load_dwordx4 v2, s[8:11], s54 offen lds
buffer_load_dwordx4 v3, s[8:11], s54 offen offset:1024 lds
s_add_u32 m0, s51, 131072
s_add_u32 s54, s50, 512
buffer_load_dwordx4 v2, s[8:11], s54 offen lds
buffer_load_dwordx4 v3, s[8:11], s54 offen offset:1024 lds
s_add_u32 m0, s51, 133120
s_add_u32 s54, s54, 32768
buffer_load_dwordx4 v2, s[8:11], s54 offen lds
buffer_load_dwordx4 v3, s[8:11], s54 offen offset:1024 lds
v_lshlrev_b32 v6, 2, v0
s_cmp_eq_u32 s3, 0
s_cselect_b32 s37, 0, 0x7fff0000
s_lshl_b32 s38, s5, 9
s_add_u32 s38, s38, 40960
s_add_u32 s38, s38, s37
v_lshlrev_b32 v13, 3, v0
v_add_u32 v8, s38, v13
s_lshl_b32 s38, s4, 7
s_add_u32 s38, s38, 45056
s_add_u32 s38, s38, s37
v_and_b32 v13, 31, v0
v_lshlrev_b32 v13, 2, v13
v_add_u32 v9, s38, v13
s_cmp_lg_u32 s3, 0
s_cbranch_scc1 L_notpoller
v_and_b32 v12, 31, v0
v_min_u32 v12, 15, v12
v_lshlrev_b32 v12, 2, v12
s_lshl_b32 s39, s5, 10
s_lshr_b32 s37, s4, 2
s_lshl_b32 s37, s37, 7
s_add_u32 s39, s39, s37
s_add_u32 s39, s39, 49152
s_mov_b32 s38, 40000
L_spin_w:
buffer_load_dword v16, v12, s[60:63], s39 offen sc1
s_waitcnt vmcnt(0)
v_cmp_eq_u32 vcc, s64, v16
s_cmp_eq_u64 vcc, -1
s_cbranch_scc1 L_found_w
s_sub_u32 s38, s38, 1
s_cmp_lg_u32 s38, 0
s_cbranch_scc1 L_spin_w
L_found_w:
s_branch L_ready_w
L_notpoller:
s_waitcnt vmcnt(0)
L_ready_w:
s_lshl_b32 s38, s5, 9
s_lshl_b32 s39, s4, 4
s_add_u32 s38, s38, s39
s_lshl_b32 s39, s3, 2
s_add_u32 s38, s38, s39
s_add_u32 s38, s38, 40960
v_mov_b32 v97, s38
v_mov_b32 v98, s64
s_mov_b64 exec, 1
buffer_store_dword v98, v97, s[60:63], 0 offen sc1
s_mov_b64 exec, -1
s_barrier
s_add_u32 m0, s51, 16384
s_add_u32 s55, s52, 0
buffer_load_dwordx4 v10, s[60:63], s55 offen offset:0 sc1 lds
buffer_load_dwordx4 v10, s[60:63], s55 offen offset:1024 sc1 lds
buffer_load_dwordx4 v10, s[60:63], s55 offen offset:2048 sc1 lds
buffer_load_dwordx4 v10, s[60:63], s55 offen offset:3072 sc1 lds
s_add_u32 m0, s51, 49152
s_add_u32 s55, s52, 16384
buffer_load_dwordx4 v10, s[60:63], s55 offen offset:0 sc1 lds
buffer_load_dwordx4 v10, s[60:63], s55 offen offset:1024 sc1 lds
buffer_load_dwordx4 v10, s[60:63], s55 offen offset:2048 sc1 lds
buffer_load_dwordx4 v10, s[60:63], s55 offen offset:3072 sc1 lds
s_add_u32 m0, s51, 81920
s_add_u32 s55, s52, 32768
buffer_load_dwordx4 v10, s[60:63], s55 offen offset:0 sc1 lds
buffer_load_dwordx4 v10, s[60:63], s55 offen offset:1024 sc1 lds
buffer_load_dwordx4 v10, s[60:63], s55 offen offset:2048 sc1 lds
buffer_load_dwordx4 v10, s[60:63], s55 offen offset:3072 sc1 lds
s_waitcnt vmcnt(8)
s_barrier
v_and_b32 v13, 31, v0
v_lshlrev_b32 v13, 2, v13
s_cmp_eq_u32 s3, 0
s_cselect_b32 s37, 0, 0x7fff0000
s_lshl_b32 s39, s5, 10
s_lshr_b32 s38, s4, 2
s_lshl_b32 s38, s38, 7
s_add_u32 s39, s39, s38
s_add_u32 s39, s39, 49152
s_add_u32 s39, s39, s37
v_add_u32 v57, s39, v13
s_cmp_eq_u32 s3, 0
s_cselect_b32 s37, 0, 0x7fff0000
v_lshrrev_b32 v12, 1, v0
v_lshlrev_b32 v12, 10, v12
v_and_b32 v13, 1, v0
v_lshl_add_u32 v12, v13, 4, v12
s_lshl_b32 s38, s5, 15
s_lshl_b32 s39, s4, 5
s_add_u32 s38, s38, s39
s_add_u32 s38, s38, 65536
s_add_u32 s38, s38, s37
v_add_u32 v62, s38, v12
s_lshl_b32 s38, s5, 10
s_lshl_b32 s39, s4, 5
s_add_u32 s38, s38, s39
s_add_u32 s38, s38, 393216
s_add_u32 s38, s38, s37
v_lshlrev_b32 v13, 4, v13
v_add_u32 v63, s38, v13
v_and_b32 v13, 31, v0
v_lshlrev_b32 v13, 2, v13
s_lshl_b32 s38, s5, 7
s_add_u32 s38, s38, 57344
s_add_u32 s38, s38, s37
v_add_u32 v92, s38, v13
s_lshl_b32 s38, s5, 10
s_add_u32 s38, s38, 393216
s_add_u32 s38, s38, s37
v_add_u32 v93, s38, v10
s_lshl_b32 s38, s4, 10
s_add_u32 s38, s38, s37
v_add_u32 v94, s38, v10
s_add_u32 m0, s51, 114688
s_add_u32 s55, s52, 49152
buffer_load_dwordx4 v10, s[60:63], s55 offen offset:0 sc1 lds
buffer_load_dwordx4 v10, s[60:63], s55 offen offset:1024 sc1 lds
buffer_load_dwordx4 v10, s[60:63], s55 offen offset:2048 sc1 lds
buffer_load_dwordx4 v10, s[60:63], s55 offen offset:3072 sc1 lds
s_waitcnt vmcnt(8)
s_barrier
s_add_u32 m0, s51, 147456
s_add_u32 s55, s52, 65536
buffer_load_dwordx4 v10, s[60:63], s55 offen offset:0 sc1 lds
buffer_load_dwordx4 v10, s[60:63], s55 offen offset:1024 sc1 lds
buffer_load_dwordx4 v10, s[60:63], s55 offen offset:2048 sc1 lds
buffer_load_dwordx4 v10, s[60:63], s55 offen offset:3072 sc1 lds
buffer_load_dword v61, v57, s[60:63], 0 offen sc1
buffer_load_dwordx2 v[58:59], v8, s[60:63], 0 offen sc1
s_waitcnt vmcnt(10)
s_barrier
s_add_u32 m0, s51, 16384
s_add_u32 s55, s52, 81920
buffer_load_dwordx4 v10, s[60:63], s55 offen offset:0 sc1 lds
buffer_load_dwordx4 v10, s[60:63], s55 offen offset:1024 sc1 lds
buffer_load_dwordx4 v10, s[60:63], s55 offen offset:2048 sc1 lds
buffer_load_dwordx4 v10, s[60:63], s55 offen offset:3072 sc1 lds
s_add_u32 m0, s51, 0
s_add_u32 s54, s50, 640
buffer_load_dwordx4 v2, s[8:11], s54 offen lds
buffer_load_dwordx4 v3, s[8:11], s54 offen offset:1024 lds
s_add_u32 m0, s51, 2048
s_add_u32 s54, s54, 32768
buffer_load_dwordx4 v2, s[8:11], s54 offen lds
buffer_load_dwordx4 v3, s[8:11], s54 offen offset:1024 lds
s_waitcnt vmcnt(14)
s_barrier
s_add_u32 m0, s51, 49152
s_add_u32 s55, s52, 98304
buffer_load_dwordx4 v10, s[60:63], s55 offen offset:0 sc1 lds
buffer_load_dwordx4 v10, s[60:63], s55 offen offset:1024 sc1 lds
buffer_load_dwordx4 v10, s[60:63], s55 offen offset:2048 sc1 lds
buffer_load_dwordx4 v10, s[60:63], s55 offen offset:3072 sc1 lds
s_add_u32 m0, s51, 32768
s_add_u32 s54, s50, 768
buffer_load_dwordx4 v2, s[8:11], s54 offen lds
buffer_load_dwordx4 v3, s[8:11], s54 offen offset:1024 lds
s_add_u32 m0, s51, 34816
s_add_u32 s54, s54, 32768
buffer_load_dwordx4 v2, s[8:11], s54 offen lds
buffer_load_dwordx4 v3, s[8:11], s54 offen offset:1024 lds
s_waitcnt vmcnt(16)
s_cmp_lg_u32 s3, 0
s_cbranch_scc1 L_ok_a
v_cmp_eq_u32 vcc, s64, v58
v_cmp_eq_u32 s[76:77], s64, v59
s_and_b64 vcc, vcc, s[76:77]
s_cmp_eq_u64 vcc, -1
s_cbranch_scc1 L_ok_a
s_mov_b32 s38, 40000
L_spin_a:
buffer_load_dwordx2 v[58:59], v8, s[60:63], 0 offen sc1
s_waitcnt vmcnt(0)
v_cmp_eq_u32 vcc, s64, v58
v_cmp_eq_u32 s[76:77], s64, v59
s_and_b64 vcc, vcc, s[76:77]
s_cmp_eq_u64 vcc, -1
s_cbranch_scc1 L_ok_a
s_sub_u32 s38, s38, 1
s_cmp_lg_u32 s38, 0
s_cbranch_scc1 L_spin_a
L_ok_a:
buffer_load_dwordx4 v[24:27], v62, s[60:63], 0 offen sc1
s_barrier
s_add_u32 m0, s51, 81920
s_add_u32 s55, s52, 114688
buffer_load_dwordx4 v10, s[60:63], s55 offen offset:0 sc1 lds
buffer_load_dwordx4 v10, s[60:63], s55 offen offset:1024 sc1 lds
buffer_load_dwordx4 v10, s[60:63], s55 offen offset:2048 sc1 lds
buffer_load_dwordx4 v10, s[60:63], s55 offen offset:3072 sc1 lds
s_add_u32 m0, s51, 65536
s_add_u32 s54, s50, 896
buffer_load_dwordx4 v2, s[8:11], s54 offen lds
buffer_load_dwordx4 v3, s[8:11], s54 offen offset:1024 lds
s_add_u32 m0, s51, 67584
s_add_u32 s54, s54, 32768
buffer_load_dwordx4 v2, s[8:11], s54 offen lds
buffer_load_dwordx4 v3, s[8:11], s54 offen offset:1024 lds
s_cmp_lg_u32 s3, 0
s_cbranch_scc1 L_ready_w2
v_cmp_eq_u32 vcc, s64, v61
s_cmp_eq_u64 vcc, -1
s_cbranch_scc1 L_ready_w2
s_mov_b32 s38, 40000
L_spin_w2:
buffer_load_dword v61, v57, s[60:63], 0 offen sc1
s_waitcnt vmcnt(0)
v_cmp_eq_u32 vcc, s64, v61
s_cmp_eq_u64 vcc, -1
s_cbranch_scc1 L_ready_w2
s_sub_u32 s38, s38, 1
s_cmp_lg_u32 s38, 0
s_cbranch_scc1 L_spin_w2
L_ready_w2:
s_waitcnt vmcnt(21)
s_waitcnt vmcnt(17)
s_barrier
s_add_u32 m0, s51, 114688
s_add_u32 s55, s52, 131072
buffer_load_dwordx4 v10, s[60:63], s55 offen offset:0 sc1 lds
buffer_load_dwordx4 v10, s[60:63], s55 offen offset:1024 sc1 lds
buffer_load_dwordx4 v10, s[60:63], s55 offen offset:2048 sc1 lds
buffer_load_dwordx4 v10, s[60:63], s55 offen offset:3072 sc1 lds
s_add_u32 m0, s51, 98304
s_add_u32 s54, s50, 1024
buffer_load_dwordx4 v2, s[8:11], s54 offen lds
buffer_load_dwordx4 v3, s[8:11], s54 offen offset:1024 lds
s_add_u32 m0, s51, 100352
s_add_u32 s54, s54, 32768
buffer_load_dwordx4 v2, s[8:11], s54 offen lds
buffer_load_dwordx4 v3, s[8:11], s54 offen offset:1024 lds
s_waitcnt vmcnt(16)
s_nop 1
v_add_f32_dpp v24, v24, v24 row_ror:2 row_mask:0xf bank_mask:0xf
v_add_f32_dpp v25, v25, v25 row_ror:2 row_mask:0xf bank_mask:0xf
v_add_f32_dpp v26, v26, v26 row_ror:2 row_mask:0xf bank_mask:0xf
v_add_f32_dpp v27, v27, v27 row_ror:2 row_mask:0xf bank_mask:0xf
s_nop 1
v_add_f32_dpp v24, v24, v24 row_ror:4 row_mask:0xf bank_mask:0xf
v_add_f32_dpp v25, v25, v25 row_ror:4 row_mask:0xf bank_mask:0xf
v_add_f32_dpp v26, v26, v26 row_ror:4 row_mask:0xf bank_mask:0xf
v_add_f32_dpp v27, v27, v27 row_ror:4 row_mask:0xf bank_mask:0xf
s_nop 1
v_add_f32_dpp v24, v24, v24 row_ror:8 row_mask:0xf bank_mask:0xf
v_add_f32_dpp v25, v25, v25 row_ror:8 row_mask:0xf bank_mask:0xf
v_add_f32_dpp v26, v26, v26 row_ror:8 row_mask:0xf bank_mask:0xf
v_add_f32_dpp v27, v27, v27 row_ror:8 row_mask:0xf bank_mask:0xf
v_mov_b32 v28, v24
v_mov_b32 v29, v25
v_mov_b32 v30, v26
v_mov_b32 v31, v27
s_nop 1
v_permlane16_swap_b32 v24, v28
v_permlane16_swap_b32 v25, v29
v_permlane16_swap_b32 v26, v30
v_permlane16_swap_b32 v27, v31
s_nop 1
v_add_f32 v24, v24, v28
v_add_f32 v25, v25, v29
v_add_f32 v26, v26, v30
v_add_f32 v27, v27, v31
v_mov_b32 v28, v24
v_mov_b32 v29, v25
v_mov_b32 v30, v26
v_mov_b32 v31, v27
s_nop 1
v_permlane32_swap_b32 v24, v28
v_permlane32_swap_b32 v25, v29
v_permlane32_swap_b32 v26, v30
v_permlane32_swap_b32 v27, v31
s_nop 1
v_add_f32 v24, v24, v28
v_add_f32 v25, v25, v29
v_add_f32 v26, v26, v30
v_add_f32 v27, v27, v31
s_mov_b64 exec, 3
buffer_store_dwordx4 v[24:27], v63, s[60:63], 0 offen sc1
s_mov_b64 exec, -1
s_barrier
s_add_u32 m0, s51, 147456
s_add_u32 s55, s52, 147456
buffer_load_dwordx4 v10, s[60:63], s55 offen offset:0 sc1 lds
buffer_load_dwordx4 v10, s[60:63], s55 offen offset:1024 sc1 lds
buffer_load_dwordx4 v10, s[60:63], s55 offen offset:2048 sc1 lds
buffer_load_dwordx4 v10, s[60:63], s55 offen offset:3072 sc1 lds
s_add_u32 m0, s51, 131072
s_add_u32 s54, s50, 1152
buffer_load_dwordx4 v2, s[8:11], s54 offen lds
buffer_load_dwordx4 v3, s[8:11], s54 offen offset:1024 lds
s_add_u32 m0, s51, 133120
s_add_u32 s54, s54, 32768
buffer_load_dwordx4 v2, s[8:11], s54 offen lds
buffer_load_dwordx4 v3, s[8:11], s54 offen offset:1024 lds
s_waitcnt vmcnt(21)
s_waitcnt vmcnt(17)
s_barrier
s_add_u32 m0, s51, 16384
s_add_u32 s55, s52, 163840
buffer_load_dwordx4 v10, s[60:63], s55 offen offset:0 sc1 lds
buffer_load_dwordx4 v10, s[60:63], s55 offen offset:1024 sc1 lds
buffer_load_dwordx4 v10, s[60:63], s55 offen offset:2048 sc1 lds
buffer_load_dwordx4 v10, s[60:63], s55 offen offset:3072 sc1 lds
s_add_u32 m0, s51, 0
s_add_u32 s54, s50, 1280
buffer_load_dwordx4 v2, s[8:11], s54 offen lds
buffer_load_dwordx4 v3, s[8:11], s54 offen offset:1024 lds
s_add_u32 m0, s51, 2048
s_add_u32 s54, s54, 32768
buffer_load_dwordx4 v2, s[8:11], s54 offen lds
buffer_load_dwordx4 v3, s[8:11], s54 offen offset:1024 lds
s_waitcnt vmcnt(16)
s_cmp_lg_u32 s3, 0
s_cbranch_scc1 L_notagA
s_lshl_b32 s38, s5, 7
s_lshl_b32 s39, s4, 2
s_add_u32 s38, s38, s39
s_add_u32 s38, s38, 57344
v_mov_b32 v97, s38
v_mov_b32 v98, s64
s_mov_b64 exec, 1
buffer_store_dword v98, v97, s[60:63], 0 offen sc1
s_mov_b64 exec, -1
L_notagA:
s_barrier
s_add_u32 m0, s51, 49152
s_add_u32 s55, s52, 180224
buffer_load_dwordx4 v10, s[60:63], s55 offen offset:0 sc1 lds
buffer_load_dwordx4 v10, s[60:63], s55 offen offset:1024 sc1 lds
buffer_load_dwordx4 v10, s[60:63], s55 offen offset:2048 sc1 lds
buffer_load_dwordx4 v10, s[60:63], s55 offen offset:3072 sc1 lds
s_add_u32 m0, s51, 32768
s_add_u32 s54, s50, 1408
buffer_load_dwordx4 v2, s[8:11], s54 offen lds
buffer_load_dwordx4 v3, s[8:11], s54 offen offset:1024 lds
s_add_u32 m0, s51, 34816
s_add_u32 s54, s54, 32768
buffer_load_dwordx4 v2, s[8:11], s54 offen lds
buffer_load_dwordx4 v3, s[8:11], s54 offen offset:1024 lds
s_waitcnt vmcnt(20)
s_waitcnt vmcnt(16)
s_barrier
s_add_u32 m0, s51, 81920
s_add_u32 s55, s52, 196608
buffer_load_dwordx4 v10, s[60:63], s55 offen offset:0 sc1 lds
buffer_load_dwordx4 v10, s[60:63], s55 offen offset:1024 sc1 lds
buffer_load_dwordx4 v10, s[60:63], s55 offen offset:2048 sc1 lds
buffer_load_dwordx4 v10, s[60:63], s55 offen offset:3072 sc1 lds
s_add_u32 m0, s51, 65536
s_add_u32 s54, s50, 1536
buffer_load_dwordx4 v2, s[8:11], s54 offen lds
buffer_load_dwordx4 v3, s[8:11], s54 offen offset:1024 lds
s_add_u32 m0, s51, 67584
s_add_u32 s54, s54, 32768
buffer_load_dwordx4 v2, s[8:11], s54 offen lds
buffer_load_dwordx4 v3, s[8:11], s54 offen offset:1024 lds
s_waitcnt vmcnt(20)
s_waitcnt vmcnt(16)
s_barrier
s_add_u32 m0, s51, 114688
s_add_u32 s55, s52, 212992
buffer_load_dwordx4 v10, s[60:63], s55 offen offset:0 sc1 lds
buffer_load_dwordx4 v10, s[60:63], s55 offen offset:1024 sc1 lds
buffer_load_dwordx4 v10, s[60:63], s55 offen offset:2048 sc1 lds
buffer_load_dwordx4 v10, s[60:63], s55 offen offset:3072 sc1 lds
s_add_u32 m0, s51, 98304
s_add_u32 s54, s50, 1664
buffer_load_dwordx4 v2, s[8:11], s54 offen lds
buffer_load_dwordx4 v3, s[8:11], s54 offen offset:1024 lds
s_add_u32 m0, s51, 100352
s_add_u32 s54, s54, 32768
buffer_load_dwordx4 v2, s[8:11], s54 offen lds
buffer_load_dwordx4 v3, s[8:11], s54 offen offset:1024 lds
buffer_load_dword v58, v92, s[60:63], 0 offen sc1
buffer_load_dword v60, v9, s[60:63], 0 offen sc1
s_waitcnt vmcnt(22)
s_waitcnt vmcnt(18)
s_barrier
s_add_u32 m0, s51, 147456
s_add_u32 s55, s52, 229376
buffer_load_dwordx4 v10, s[60:63], s55 offen offset:0 sc1 lds
buffer_load_dwordx4 v10, s[60:63], s55 offen offset:1024 sc1 lds
buffer_load_dwordx4 v10, s[60:63], s55 offen offset:2048 sc1 lds
buffer_load_dwordx4 v10, s[60:63], s55 offen offset:3072 sc1 lds
s_add_u32 m0, s51, 131072
s_add_u32 s54, s50, 1792
buffer_load_dwordx4 v2, s[8:11], s54 offen lds
buffer_load_dwordx4 v3, s[8:11], s54 offen offset:1024 lds
s_add_u32 m0, s51, 133120
s_add_u32 s54, s54, 32768
buffer_load_dwordx4 v2, s[8:11], s54 offen lds
buffer_load_dwordx4 v3, s[8:11], s54 offen offset:1024 lds
s_waitcnt vmcnt(22)
s_waitcnt vmcnt(18)
s_barrier
s_add_u32 m0, s51, 16384
s_add_u32 s55, s52, 245760
buffer_load_dwordx4 v10, s[60:63], s55 offen offset:0 sc1 lds
buffer_load_dwordx4 v10, s[60:63], s55 offen offset:1024 sc1 lds
buffer_load_dwordx4 v10, s[60:63], s55 offen offset:2048 sc1 lds
buffer_load_dwordx4 v10, s[60:63], s55 offen offset:3072 sc1 lds
s_add_u32 m0, s51, 0
s_add_u32 s54, s50, 1920
buffer_load_dwordx4 v2, s[8:11], s54 offen lds
buffer_load_dwordx4 v3, s[8:11], s54 offen offset:1024 lds
s_add_u32 m0, s51, 2048
s_add_u32 s54, s54, 32768
buffer_load_dwordx4 v2, s[8:11], s54 offen lds
buffer_load_dwordx4 v3, s[8:11], s54 offen offset:1024 lds
s_waitcnt vmcnt(16)
s_cmp_lg_u32 s3, 0
s_cbranch_scc1 L_ok_b
v_cmp_eq_u32 vcc, s64, v58
v_cmp_eq_u32 s[76:77], s64, v60
s_and_b64 vcc, vcc, s[76:77]
s_cmp_eq_u64 vcc, -1
s_cbranch_scc1 L_ok_b
s_mov_b32 s38, 40000
L_spin_b:
buffer_load_dword v58, v92, s[60:63], 0 offen sc1
buffer_load_dword v60, v9, s[60:63], 0 offen sc1
s_waitcnt vmcnt(0)
v_cmp_eq_u32 vcc, s64, v58
v_cmp_eq_u32 s[76:77], s64, v60
s_and_b64 vcc, vcc, s[76:77]
s_cmp_eq_u64 vcc, -1
s_cbranch_scc1 L_ok_b
s_sub_u32 s38, s38, 1
s_cmp_lg_u32 s38, 0
s_cbranch_scc1 L_spin_b
L_ok_b:
buffer_load_dwordx4 v[24:27], v93, s[60:63], 0 offen sc1
buffer_load_dwordx4 v[28:31], v94, s[60:63], 0 offen sc1
s_barrier
s_waitcnt vmcnt(14)
s_waitcnt vmcnt(10)
s_barrier
s_waitcnt vmcnt(0)
s_cmp_lg_u32 s3, 0
s_cbranch_scc1 L_notab
v_add_u32 v12, 32768, v10
ds_write_b128 v12, v[24:27]
ds_write_b128 v12, v[28:31] offset:1024
s_waitcnt lgkmcnt(0)
L_notab:
s_barrier
s_or_b32 s38, s2, s3
s_cmp_lg_u32 s38, 0
s_cbranch_scc1 L_noepoch
v_lshrrev_b32 v12, 3, v0
v_lshlrev_b32 v12, 10, v12
v_and_b32 v13, 7, v0
v_lshl_add_u32 v12, v13, 4, v12
s_mov_b32 s38, 40000
L_spin_e:
s_mov_b32 s39, 49152
buffer_load_dwordx4 v[16:19], v12, s[60:63], s39 offen sc1
s_waitcnt vmcnt(0)
s_mov_b64 s[76:77], -1
v_cmp_eq_u32 vcc, s64, v16
s_and_b64 s[76:77], s[76:77], vcc
v_cmp_eq_u32 vcc, s64, v17
s_and_b64 s[76:77], s[76:77], vcc
v_cmp_eq_u32 vcc, s64, v18
s_and_b64 s[76:77], s[76:77], vcc
v_cmp_eq_u32 vcc, s64, v19
s_and_b64 s[76:77], s[76:77], vcc
s_cmp_eq_u64 s[76:77], -1
s_cbranch_scc1 L_doepoch
s_sub_u32 s38, s38, 1
s_cmp_lg_u32 s38, 0
s_cbranch_scc1 L_spin_e
L_doepoch:
v_mov_b32 v12, 32768
v_mov_b32 v13, s64
s_mov_b64 exec, 1
buffer_store_dword v13, v12, s[60:63], 0 offen sc1
s_mov_b64 exec, -1
L_noepoch:
L_end:
L_exit:
s_endpgm
L_codeend:
.section .rodata,"a"
.p2align 6
.amdhsa_kernel standalone__layernorm_linear__prompt_kernel
  .amdhsa_next_free_vgpr 224
  .amdhsa_next_free_sgpr 96
  .amdhsa_accum_offset 224
  .amdhsa_group_segment_fixed_size 0
  .amdhsa_kernarg_size 56
  .amdhsa_user_sgpr_count 2
  .amdhsa_user_sgpr_kernarg_segment_ptr 1
  .amdhsa_system_sgpr_workgroup_id_x 1
.end_amdhsa_kernel
```
